```python
import torch

def _softmax(x, axis=-1):
    return torch.softmax(x, dim=axis)
def _gelu(x):
    return torch.nn.functional.gelu(x, approximate="tanh")
def _silu(x):
    return torch.nn.functional.silu(x)
def _sigmoid(x):
    return torch.sigmoid(x)
def _layernorm(x, axis=-1, eps=1e-5):
    m = x.mean(dim=axis, keepdim=True)
    v = x.var(dim=axis, keepdim=True, unbiased=False)
    return (x - m) / torch.sqrt(v + eps)
def _scatter_add(tgt, idx, src, axis=0):
    return tgt.clone().index_add_(axis, idx, src)
def _segment_sum(src, seg, n):
    out = torch.zeros((n,) + src.shape[1:], dtype=src.dtype)
    return out.index_add_(0, seg, src)
def _pad(x, pw):
    flat = tuple(v for pair in reversed(pw) for v in pair)
    return torch.nn.functional.pad(x, flat)

kernel_name = 'recurrent_scan__sliding_block_cached__dense_activation_silu__decode'

def setup_inputs():

    _w = (lambda a: (lambda t: t.to(torch.bfloat16) if t.is_floating_point() else t)(torch.as_tensor(a)))
    def _A_setup():
        B, Sq, D = 4, 1, 576
        Hq, Hkv, Sk, Dh = 32, 16, 4096, 128
        assert Hq % Hkv == 0, (Hq, Hkv)
        return {
            "x": _w((lambda *s: torch.randn(*s, dtype=torch.bfloat16) * 0.1)(B, Sq, D)),
            "k_cache": _w((lambda *s: torch.randn(*s, dtype=torch.bfloat16) * 0.8)(B, Hkv, Sk, Dh)),
            "v_cache": _w((lambda *s: torch.randn(*s, dtype=torch.bfloat16) * 3.2)(B, Hkv, Sk, Dh)),
            "wq": _w((lambda *s: torch.randn(*s, dtype=torch.bfloat16) * 0.8)(D, Hq * Dh) * (D ** -0.5)),
            "wo": _w((lambda *s: torch.randn(*s, dtype=torch.bfloat16) * 3.2)(Hq * Dh, D) * ((Hq * Dh) ** -0.5)),
        }
    _A_in = _A_setup()

    def _B_setup():
        B, S, D, F = 4, 1, 576, 4608
        return {
            "x": _w((lambda *s: torch.randn(*s, dtype=torch.bfloat16) * 0.1)(B, S, D)),
            "w1": _w((lambda *s: torch.randn(*s, dtype=torch.bfloat16) * 3.2)(D, F) * (D ** -0.5)),
            "w2": _w((lambda *s: torch.randn(*s, dtype=torch.bfloat16) * 3.2)(F, D) * (F ** -0.5)),
        }
    _B_in = _B_setup()

    return {
        "A_x": _A_in["x"],
        "A_k_cache": _A_in["k_cache"],
        "A_v_cache": _A_in["v_cache"],
        "A_wq": _A_in["wq"],
        "A_wo": _A_in["wo"],
        "B_x": _B_in["x"],
        "B_w1": _B_in["w1"],
        "B_w2": _B_in["w2"],
    }

def reference(A_x, A_k_cache, A_v_cache, A_wq, A_wo, B_x, B_w1, B_w2):
    def _A_ref(x, k_cache, v_cache, wq, wo):
        B, Sq, D = x.shape
        Hq, Dh = 32, 128
        Hkv, Sk = k_cache.shape[1], k_cache.shape[2]
        W = min(4096, max(256, Sk // 4))
        rep = Hq // Hkv
        q = (lambda x, *d: x.permute(*d))((x @ wq).reshape(B, Sq, Hq, Dh), 0, 2, 1, 3)
        k = (lambda x, n, axis: torch.repeat_interleave(x, n, dim=axis))(k_cache[:, :, Sk - W:, :], rep, axis=1)
        v = (lambda x, n, axis: torch.repeat_interleave(x, n, dim=axis))(v_cache[:, :, Sk - W:, :], rep, axis=1)
        scores = torch.einsum("bhqd,bhkd->bhqk", q, k) * (Dh ** -0.5)
        p = _softmax(scores, axis=-1)
        o = torch.einsum("bhqk,bhkd->bhqd", p, v)
        return (lambda x, *d: x.permute(*d))(o, 0, 2, 1, 3).reshape(B, Sq, Hq * Dh) @ wo

    def _B_ref(x, w1, w2):
        h = torch.einsum("bsd,df->bsf", x, w1)
        h = _silu(h)
        out = torch.einsum("bsf,fd->bsd", h, w2)
        return out

    x = A_x
    xn = _layernorm(x, axis=-1)
    s = _A_ref(xn, A_k_cache, A_v_cache, A_wq, A_wo)
    g = _silu(_B_ref(xn, B_w1, B_w2))
    return x + s * g
```

```asm
; @launch grid=(256,1,1) block=(512,1,1) lds=109056
.amdgcn_target "amdgcn-amd-amdhsa--gfx950"
.text
.p2align 12
.fill 64, 4, 0xbf810000
.globl recurrent_scan__sliding_block_cached__dense_activation_silu__decode_kernel
.p2align 8
.type recurrent_scan__sliding_block_cached__dense_activation_silu__decode_kernel,@function
recurrent_scan__sliding_block_cached__dense_activation_silu__decode_kernel:
L_start:
    s_load_dwordx16 s[4:19], s[0:1], 0
    s_load_dwordx4 s[20:23], s[0:1], 64
    s_load_dwordx2 s[24:25], s[0:1], 80
    s_cmp_ge_u32 s2, 256
    s_cbranch_scc1 L_end
    v_lshrrev_b32 v1, 6, v0
    s_nop 0
    v_readfirstlane_b32 s3, v1
    v_and_b32 v1, 63, v0
    v_mov_b32 v38, 0
    v_mov_b32 v39, 1
    s_and_b32 s68, s2, 7
    s_lshr_b32 s69, s2, 3
    s_cmp_lt_u32 s3, 4
    s_cbranch_scc1 L_KV
    s_setprio 3
    s_sub_u32 s3, s3, 4
    s_mul_i32 s60, s3, 1152
    v_mul_u32_u24 v2, 16, v1
    v_lshlrev_b32 v4, 2, v1
    s_mov_b64 exec, 0xff
    ds_write_b32 v4, v38 offset:6464
    s_mov_b32 s30, 0x1200
    s_mov_b32 s31, 0x20000
    s_mov_b32 exec_lo, -1
    s_mov_b32 exec_hi, 15
    s_waitcnt lgkmcnt(0)
    s_mov_b32 s28, s4
    s_mov_b32 s29, s5
    buffer_load_dwordx4 v[104:107], v2, s[28:31], s60 offen
    buffer_load_dwordx4 v[108:111], v2, s[28:31], s60 offen offset:576
    s_barrier
    s_mov_b32 exec_hi, -1
    s_load_dword s26, s[24:25], 0
    s_mov_b64 exec, 0
    s_cmp_eq_u32 s3, 0
    s_cbranch_scc1 L_pad3
    s_cmp_eq_u32 s3, 1
    s_cbranch_scc1 L_pad4
    s_cmp_eq_u32 s3, 2
    s_cbranch_scc1 L_pad5
    s_cmp_eq_u32 s3, 3
    s_cbranch_scc1 L_pad6
L_ret1:
    s_mov_b64 exec, -1
    s_branch L_w_ln
L_KV:
    v_lshrrev_b32 v5, 3, v1
    v_bfe_u32 v6, v1, 1, 2
    v_bfe_u32 v7, v1, 4, 2
    v_xor_b32 v6, v6, v7
    v_lshlrev_b32 v6, 5, v6
    v_and_b32 v7, 1, v1
    v_lshl_add_u32 v6, v7, 4, v6
    v_lshl_add_u32 v30, v5, 13, v6
    s_lshl_b32 s67, s3, 10
    s_add_u32 m0, s67, 10752
    s_lshl_b32 s63, s68, 1
    s_and_b32 s61, s69, 1
    s_add_u32 s63, s63, s61
    s_bfe_u32 s64, s69, 0x20001
    s_lshl_b32 s58, s63, 2
    s_add_u32 s58, s58, s64
    s_lshl_b32 s58, s58, 7
    s_lshr_b32 s62, s69, 3
    s_mul_i32 s61, s62, 1179648
    s_add_u32 s58, s58, s61
    s_lshl_b32 s61, s3, 16
    s_add_u32 s58, s58, s61
    s_lshl_b32 s62, s62, 4
    s_add_u32 s63, s63, s62
    s_mov_b32 s34, 0x480000
    s_mov_b32 s35, 0x20000
    s_waitcnt lgkmcnt(0)
    s_mov_b32 s32, s10
    s_mov_b32 s33, s11
    buffer_load_dwordx4 v30, s[32:35], s58 offen nt lds
    s_add_u32 m0, m0, 0x1000
    s_add_u32 s58, s58, 262144
    s_mov_b32 s28, s6
    s_mov_b32 s29, s7
    s_mov_b32 s36, s16
    s_mov_b32 s37, s17
    buffer_load_dwordx4 v30, s[32:35], s58 offen nt lds
    s_add_u32 m0, m0, 0x1000
    s_add_u32 s58, s58, 262144
    buffer_load_dwordx4 v30, s[32:35], s58 offen nt lds
    s_add_u32 m0, m0, 0x1000
    s_add_u32 s58, s58, 262144
    buffer_load_dwordx4 v30, s[32:35], s58 offen nt lds
    s_add_u32 m0, m0, 0x1000
    s_add_u32 s58, s58, 262144
    s_cmp_ge_u32 s3, 2
    s_cbranch_scc1 L_kv_q4
    buffer_load_dwordx4 v30, s[32:35], s58 offen nt lds
L_kv_q4:
    s_add_u32 m0, s67, 29184
    s_lshl_b32 s60, s63, 20
    s_lshl_b32 s61, s64, 16
    s_add_u32 s60, s60, s61
    s_add_u32 s60, s60, s67
    s_add_u32 s60, s60, 0xc0000
    s_mul_i32 s61, s69, 20480
    s_mul_i32 s62, s68, 12288
    s_add_u32 s61, s61, s62
    s_mul_i32 s62, s3, 8192
    s_xor_b32 s61, s61, s62
    s_and_b32 s61, s61, 0xf000
    s_add_u32 s40, s60, s61
    v_lshlrev_b32 v3, 4, v1
    v_bfe_u32 v2, v1, 2, 2
    v_lshlrev_b32 v2, 8, v2
    v_lshrrev_b32 v4, 4, v1
    v_lshl_add_u32 v2, v4, 6, v2
    v_and_b32 v4, 3, v1
    v_lshl_add_u32 v2, v4, 4, v2
    s_mov_b32 s30, 0x4000000
    s_mov_b32 s31, 0x20000
    s_mov_b32 s60, 9216
    v_mad_u32_u24 v29, v5, s60, v6
    s_add_u32 s60, s69, 2
    s_and_b32 s60, s60, 7
    s_lshl_b32 s60, s60, 2
    s_lshr_b32 s61, s69, 3
    s_add_u32 s60, s60, s61
    s_sub_u32 s61, s60, 3
    s_cmp_lt_u32 s60, 4
    s_cselect_b32 s61, s60, s61
    s_lshr_b32 s65, s61, 3
    s_and_b32 s42, s61, 7
    s_add_u32 s42, s42, 1
    s_sub_u32 s61, s60, 4
    s_cmp_lt_u32 s61, 3
    s_cselect_b32 s65, s61, s65
    s_cselect_b32 s42, 0, s42
    s_sub_u32 s61, 3, s68
    s_and_b32 s61, s61, 7
    s_add_u32 s42, s42, s61
    s_sub_u32 s61, s42, 9
    s_cmp_ge_u32 s42, 9
    s_cselect_b32 s42, s61, s42
    s_mul_i32 s61, s68, 9
    s_add_u32 s42, s42, s61
    s_mov_b32 s57, s60
    s_mul_i32 s66, s65, 1769472
    s_lshl_b32 s61, s42, 7
    s_add_u32 s66, s66, s61
    s_mul_i32 s61, s3, 73728
    s_add_u32 s66, s66, s61
    s_cmp_ge_u32 s65, 3
    s_cselect_b32 s38, 0, 0x510000
    s_cselect_b32 s66, 0, s66
    s_mov_b32 s39, 0x20000
    s_barrier
    buffer_load_dwordx4 v29, s[36:39], s66 offen nt lds
    s_add_u32 m0, m0, 0x1000
    s_add_u32 s66, s66, 294912
    buffer_load_dwordx4 v[40:43], v2, s[28:31], s40 offen nt
    buffer_load_dwordx4 v29, s[36:39], s66 offen nt lds
    s_add_u32 m0, m0, 0x1000
    s_add_u32 s66, s66, 294912
    s_xor_b32 s41, s40, 0x1000
    buffer_load_dwordx4 v[44:47], v2, s[28:31], s41 offen nt
    buffer_load_dwordx4 v29, s[36:39], s66 offen nt lds
    s_add_u32 m0, m0, 0x1000
    s_add_u32 s66, s66, 294912
    s_xor_b32 s42, s40, 0x2000
    buffer_load_dwordx4 v[48:51], v2, s[28:31], s42 offen nt
    s_load_dword s26, s[24:25], 0
    s_mov_b32 s32, s8
    s_mov_b32 s33, s9
    s_mov_b32 s34, 0x4000000
    s_mov_b32 s35, 0x20000
    s_mov_b64 exec, 0
    s_cmp_eq_u32 s3, 0
    s_cbranch_scc1 L_pad0
    s_cmp_eq_u32 s3, 1
    s_cbranch_scc1 L_pad1
    s_cmp_eq_u32 s3, 2
    s_cbranch_scc1 L_pad2
    s_cmp_eq_u32 s3, 3
    s_cbranch_scc1 L_pad7
L_ret3:
    s_mov_b64 exec, -1
    v_and_b32 v8, 1, v1
    v_cmp_eq_u32 vcc, 1, v8
    v_mov_b32 v9, 0xffff
    v_mov_b32 v10, 0xffff0000
    v_cndmask_b32 v8, v9, v10, vcc
    v_bfe_u32 v9, v1, 1, 2
    v_cmp_eq_u32 vcc, 0, v9
    s_nop 1
    v_cndmask_b32 v4, 0, v8, vcc
    v_cmp_eq_u32 vcc, 1, v9
    s_nop 1
    v_cndmask_b32 v5, 0, v8, vcc
    v_cmp_eq_u32 vcc, 2, v9
    s_nop 1
    v_cndmask_b32 v6, 0, v8, vcc
    v_cmp_eq_u32 vcc, 3, v9
    s_nop 1
    v_cndmask_b32 v7, 0, v8, vcc
    v_bfe_u32 v18, v1, 3, 1
    v_lshlrev_b32 v19, 8, v18
L_pad0:
    s_cbranch_execz L_ret3
    v_lshrrev_b32 v20, 4, v1
    v_lshl_add_u32 v19, v20, 6, v19
    v_and_b32 v20, 3, v1
    v_lshl_add_u32 v19, v20, 4, v19
    s_lshl_b32 s60, s3, 2
    v_lshl_add_u32 v36, v18, 4, s60
    v_lshrrev_b32 v37, 5, v1
    v_lshlrev_b32 v37, 4, v37
    v_add_u32 v28, s60, v37
    s_mov_b32 s60, 0x70
    s_bitcmp1_b32 s60, s57
    s_cselect_b64 vcc, -1, 0
    s_waitcnt vmcnt(6)
    s_mov_b64 exec, 1
    ds_add_u32 v38, v39 offset:6492
    s_mov_b64 exec, -1
    s_waitcnt vmcnt(7)
    s_cbranch_vccnz L_bo1
    s_waitcnt vmcnt(5)
L_bo1:
    buffer_load_dwordx4 v29, s[36:39], s66 offen nt lds
    s_add_u32 m0, m0, 0x1000
    s_add_u32 s66, s66, 294912
    s_xor_b32 s43, s40, 0x3000
    s_waitcnt vmcnt(7)
    s_cbranch_vccnz L_bo2
    s_waitcnt vmcnt(5)
L_bo2:
    buffer_load_dwordx4 v[52:55], v2, s[28:31], s43 offen nt
    s_waitcnt vmcnt(7)
    s_cbranch_vccnz L_bo3
    s_waitcnt vmcnt(5)
L_bo3:
    buffer_load_dwordx4 v29, s[36:39], s66 offen nt lds
    s_add_u32 m0, m0, 0x1000
    s_add_u32 s66, s66, 294912
    s_xor_b32 s44, s40, 0x4000
    s_waitcnt vmcnt(7)
    s_cbranch_vccnz L_bo4
    s_waitcnt vmcnt(5)
L_bo4:
    buffer_load_dwordx4 v[56:59], v2, s[28:31], s44 offen nt
    s_waitcnt vmcnt(7)
    s_cbranch_vccnz L_bo5
    s_waitcnt vmcnt(5)
L_bo5:
    buffer_load_dwordx4 v29, s[36:39], s66 offen nt lds
    s_xor_b32 s45, s40, 0x5000
    s_waitcnt vmcnt(7)
    s_cbranch_vccnz L_bo6
    s_waitcnt vmcnt(5)
L_bo6:
    buffer_load_dwordx4 v[60:63], v2, s[28:31], s45 offen nt
    s_xor_b32 s46, s40, 0x6000
    s_waitcnt vmcnt(7)
    s_cbranch_vccnz L_bo7
    s_waitcnt vmcnt(5)
L_bo7:
    buffer_load_dwordx4 v[64:67], v2, s[28:31], s46 offen nt
    s_xor_b32 s47, s40, 0x7000
    s_waitcnt vmcnt(7)
    s_cbranch_vccnz L_bo8
    s_waitcnt vmcnt(5)
L_bo8:
    buffer_load_dwordx4 v[68:71], v2, s[28:31], s47 offen nt
    s_xor_b32 s48, s40, 0x8000
    s_waitcnt vmcnt(7)
    s_cbranch_vccnz L_bo9
    s_waitcnt vmcnt(5)
L_bo9:
    buffer_load_dwordx4 v[72:75], v2, s[28:31], s48 offen nt
    s_xor_b32 s49, s40, 0x9000
    s_waitcnt vmcnt(7)
    s_cbranch_vccnz L_bo10
    s_waitcnt vmcnt(5)
L_bo10:
    buffer_load_dwordx4 v[76:79], v2, s[28:31], s49 offen nt
    s_xor_b32 s50, s40, 0xa000
    s_waitcnt vmcnt(7)
    s_cbranch_vccnz L_bo11
    s_waitcnt vmcnt(5)
L_bo11:
    buffer_load_dwordx4 v[80:83], v2, s[28:31], s50 offen nt
    s_xor_b32 s51, s40, 0xb000
    s_waitcnt vmcnt(7)
    s_cbranch_vccnz L_bo12
    s_waitcnt vmcnt(5)
L_bo12:
    buffer_load_dwordx4 v[84:87], v2, s[28:31], s51 offen nt
    s_xor_b32 s52, s40, 0xc000
    s_waitcnt vmcnt(7)
    s_cbranch_vccnz L_bo13
    s_waitcnt vmcnt(5)
L_bo13:
    buffer_load_dwordx4 v[88:91], v2, s[28:31], s52 offen nt
    s_mov_b64 exec, 1
    ds_add_u32 v38, v39 offset:6476
    s_mov_b64 exec, -1
    s_xor_b32 s53, s40, 0xd000
    s_waitcnt vmcnt(7)
    s_cbranch_vccnz L_bo14
    s_waitcnt vmcnt(5)
L_bo14:
    buffer_load_dwordx4 v[92:95], v2, s[28:31], s53 offen nt
    s_xor_b32 s54, s40, 0xe000
    s_waitcnt vmcnt(7)
    s_cbranch_vccnz L_bo15
    s_waitcnt vmcnt(5)
L_bo15:
    buffer_load_dwordx4 v[96:99], v2, s[28:31], s54 offen nt
    s_xor_b32 s55, s40, 0xf000
    s_waitcnt vmcnt(7)
    s_cbranch_vccnz L_bo16
    s_waitcnt vmcnt(5)
L_bo16:
    buffer_load_dwordx4 v[100:103], v2, s[28:31], s55 offen nt
    s_mov_b32 s36, s24
    s_mov_b32 s37, s25
    s_mov_b32 s38, 0x400000
    s_mov_b32 s39, 0x20000
    s_waitcnt vmcnt(7)
    s_cbranch_vccnz L_bo17
    s_waitcnt vmcnt(5)
L_bo17:
    buffer_load_dwordx4 v[104:107], v3, s[32:35], s40 offen nt
    s_waitcnt vmcnt(7)
    s_cbranch_vccnz L_bo18
    s_waitcnt vmcnt(5)
L_bo18:
    buffer_load_dwordx4 v[108:111], v3, s[32:35], s41 offen nt
    s_waitcnt vmcnt(7)
    s_cbranch_vccnz L_bo19
    s_waitcnt vmcnt(5)
L_bo19:
    buffer_load_dwordx4 v[112:115], v3, s[32:35], s42 offen nt
    s_waitcnt vmcnt(7)
    s_cbranch_vccnz L_bo20
    s_waitcnt vmcnt(5)
L_bo20:
    buffer_load_dwordx4 v[116:119], v3, s[32:35], s43 offen nt
    s_waitcnt vmcnt(7)
    s_cbranch_vccnz L_bo21
    s_waitcnt vmcnt(5)
L_bo21:
    buffer_load_dwordx4 v[120:123], v3, s[32:35], s44 offen nt
    s_waitcnt vmcnt(7)
    s_cbranch_vccnz L_bo22
    s_waitcnt vmcnt(5)
L_bo22:
    buffer_load_dwordx4 v[124:127], v3, s[32:35], s45 offen nt
    s_waitcnt vmcnt(7)
    s_cbranch_vccnz L_bo23
    s_waitcnt vmcnt(5)
L_bo23:
    buffer_load_dwordx4 v[128:131], v3, s[32:35], s46 offen nt
    s_waitcnt vmcnt(7)
    s_cbranch_vccnz L_bo24
    s_waitcnt vmcnt(5)
L_bo24:
    buffer_load_dwordx4 v[132:135], v3, s[32:35], s47 offen nt
    s_waitcnt vmcnt(7)
    s_cbranch_vccnz L_bo25
    s_waitcnt vmcnt(5)
L_bo25:
    buffer_load_dwordx4 v[136:139], v3, s[32:35], s48 offen nt
    s_waitcnt vmcnt(5)
    buffer_load_dwordx4 v[140:143], v3, s[32:35], s49 offen nt
    s_setprio 2
    s_mov_b32 s62, 0
L_aw26:
    s_add_u32 s62, s62, 1
    s_cmp_ge_u32 s62, 1000000
    s_cbranch_scc1 L_fail
    ds_read_b32 v32, v38 offset:6480
    ds_read_b128 v[8:11], v19 offset:4736
    s_waitcnt lgkmcnt(0)
    v_readfirstlane_b32 s60, v32
    s_nop 0
    s_cmp_ge_u32 s60, 1
    s_cbranch_scc0 L_aw26
    s_mov_b32 s59, s60
    s_add_u32 s27, s26, 0x6d2b79f5
    s_getreg_b32 s58, hwreg(HW_REG_XCC_ID)
    s_and_b32 s58, s58, 7
    s_mul_i32 s58, s58, 0x01010101
    s_xor_b32 s58, s58, s27
    s_waitcnt vmcnt(5)
    buffer_load_dwordx4 v[144:147], v3, s[32:35], s50 offen nt
    s_mov_b32 s66, 0xf0f0f0f0
    s_mov_b32 s67, 0xf0f0f0f0
    v_cndmask_b32 v24, 0, v8, s[66:67]
    v_cndmask_b32 v25, 0, v9, s[66:67]
    v_cndmask_b32 v26, 0, v10, s[66:67]
    v_cndmask_b32 v27, 0, v11, s[66:67]
    v_cndmask_b32 v8, v8, 0, s[66:67]
    v_cndmask_b32 v9, v9, 0, s[66:67]
    v_cndmask_b32 v10, v10, 0, s[66:67]
    v_cndmask_b32 v11, v11, 0, s[66:67]
    v_mfma_f32_16x16x32_bf16 v[32:35], v[44:47], v[24:27], 0
    s_nop 0
    v_mfma_f32_16x16x32_bf16 v[32:35], v[40:43], v[8:11], v[32:35]
    v_mfma_f32_16x16x32_bf16 v[40:43], v[52:55], v[24:27], 0
    v_mfma_f32_16x16x32_bf16 v[40:43], v[48:51], v[8:11], v[40:43]
    v_mfma_f32_16x16x32_bf16 v[48:51], v[60:63], v[24:27], 0
    v_mfma_f32_16x16x32_bf16 v[48:51], v[56:59], v[8:11], v[48:51]
    s_nop 3
    v_mov_b32_dpp v16, v32 quad_perm:[0,0,0,0] row_mask:0xf bank_mask:0xf
    v_mfma_f32_16x16x32_bf16 v[56:59], v[68:71], v[24:27], 0
    v_mfma_f32_16x16x32_bf16 v[56:59], v[64:67], v[8:11], v[56:59]
    v_add_f32_dpp v16, v33, v16 quad_perm:[1,1,1,1] row_mask:0xf bank_mask:0xf
    v_mov_b32_dpp v17, v40 quad_perm:[0,0,0,0] row_mask:0xf bank_mask:0xf
    v_mfma_f32_16x16x32_bf16 v[64:67], v[76:79], v[24:27], 0
    v_mfma_f32_16x16x32_bf16 v[64:67], v[72:75], v[8:11], v[64:67]
    v_add_f32_dpp v16, v34, v16 quad_perm:[2,2,2,2] row_mask:0xf bank_mask:0xf
    v_add_f32_dpp v17, v41, v17 quad_perm:[1,1,1,1] row_mask:0xf bank_mask:0xf
L_pad1:
    s_cbranch_execz L_ret3
    v_mov_b32_dpp v18, v48 quad_perm:[0,0,0,0] row_mask:0xf bank_mask:0xf
    v_mfma_f32_16x16x32_bf16 v[72:75], v[84:87], v[24:27], 0
    v_mfma_f32_16x16x32_bf16 v[72:75], v[80:83], v[8:11], v[72:75]
    v_add_f32_dpp v16, v35, v16 quad_perm:[3,3,3,3] row_mask:0xf bank_mask:0xf
    v_add_f32_dpp v17, v42, v17 quad_perm:[2,2,2,2] row_mask:0xf bank_mask:0xf
    v_add_f32_dpp v18, v49, v18 quad_perm:[1,1,1,1] row_mask:0xf bank_mask:0xf
    v_mov_b32_dpp v19, v56 quad_perm:[0,0,0,0] row_mask:0xf bank_mask:0xf
    v_mfma_f32_16x16x32_bf16 v[80:83], v[92:95], v[24:27], 0
    v_mfma_f32_16x16x32_bf16 v[80:83], v[88:91], v[8:11], v[80:83]
    v_add_f32_dpp v17, v43, v17 quad_perm:[3,3,3,3] row_mask:0xf bank_mask:0xf
    s_waitcnt vmcnt(5)
    buffer_load_dwordx4 v[148:151], v3, s[32:35], s51 offen nt
    v_add_f32_dpp v18, v50, v18 quad_perm:[2,2,2,2] row_mask:0xf bank_mask:0xf
    v_add_f32_dpp v19, v57, v19 quad_perm:[1,1,1,1] row_mask:0xf bank_mask:0xf
    v_mov_b32_dpp v20, v64 quad_perm:[0,0,0,0] row_mask:0xf bank_mask:0xf
    v_mfma_f32_16x16x32_bf16 v[88:91], v[100:103], v[24:27], 0
    v_mfma_f32_16x16x32_bf16 v[88:91], v[96:99], v[8:11], v[88:91]
    v_add_f32_dpp v18, v51, v18 quad_perm:[3,3,3,3] row_mask:0xf bank_mask:0xf
    v_add_f32_dpp v19, v58, v19 quad_perm:[2,2,2,2] row_mask:0xf bank_mask:0xf
    v_add_f32_dpp v20, v65, v20 quad_perm:[1,1,1,1] row_mask:0xf bank_mask:0xf
    v_mov_b32_dpp v21, v72 quad_perm:[0,0,0,0] row_mask:0xf bank_mask:0xf
    s_mov_b32 s61, 0x3db504f3
    v_add_f32_dpp v19, v59, v19 quad_perm:[3,3,3,3] row_mask:0xf bank_mask:0xf
    v_add_f32_dpp v20, v66, v20 quad_perm:[2,2,2,2] row_mask:0xf bank_mask:0xf
    v_add_f32_dpp v21, v73, v21 quad_perm:[1,1,1,1] row_mask:0xf bank_mask:0xf
    v_mov_b32_dpp v22, v80 quad_perm:[0,0,0,0] row_mask:0xf bank_mask:0xf
    v_add_f32_dpp v20, v67, v20 quad_perm:[3,3,3,3] row_mask:0xf bank_mask:0xf
    v_add_f32_dpp v21, v74, v21 quad_perm:[2,2,2,2] row_mask:0xf bank_mask:0xf
    v_add_f32_dpp v22, v81, v22 quad_perm:[1,1,1,1] row_mask:0xf bank_mask:0xf
    v_mov_b32_dpp v23, v88 quad_perm:[0,0,0,0] row_mask:0xf bank_mask:0xf
    v_cvt_pk_bf16_f32 v17, v16, v17
    v_lshlrev_b32 v16, 16, v17
    v_and_b32 v17, 0xffff0000, v17
    v_mul_f32 v16, s61, v16
    v_mul_f32 v17, s61, v17
    v_cvt_pk_bf16_f32 v17, v16, v17
    v_lshlrev_b32 v16, 16, v17
    v_and_b32 v17, 0xffff0000, v17
    v_add_f32_dpp v21, v75, v21 quad_perm:[3,3,3,3] row_mask:0xf bank_mask:0xf
    v_add_f32_dpp v22, v82, v22 quad_perm:[2,2,2,2] row_mask:0xf bank_mask:0xf
    v_add_f32_dpp v23, v89, v23 quad_perm:[1,1,1,1] row_mask:0xf bank_mask:0xf
    v_cvt_pk_bf16_f32 v19, v18, v19
    v_lshlrev_b32 v18, 16, v19
    v_and_b32 v19, 0xffff0000, v19
    v_mul_f32 v18, s61, v18
    v_mul_f32 v19, s61, v19
    v_cvt_pk_bf16_f32 v19, v18, v19
    s_waitcnt vmcnt(5)
    buffer_load_dwordx4 v[152:155], v3, s[32:35], s52 offen nt
    v_lshlrev_b32 v18, 16, v19
    v_and_b32 v19, 0xffff0000, v19
    v_add_f32_dpp v22, v83, v22 quad_perm:[3,3,3,3] row_mask:0xf bank_mask:0xf
    v_add_f32_dpp v23, v90, v23 quad_perm:[2,2,2,2] row_mask:0xf bank_mask:0xf
    v_cvt_pk_bf16_f32 v21, v20, v21
    v_lshlrev_b32 v20, 16, v21
    v_and_b32 v21, 0xffff0000, v21
    v_mul_f32 v20, s61, v20
    v_mul_f32 v21, s61, v21
    v_cvt_pk_bf16_f32 v21, v20, v21
    v_lshlrev_b32 v20, 16, v21
    v_and_b32 v21, 0xffff0000, v21
    v_add_f32_dpp v23, v91, v23 quad_perm:[3,3,3,3] row_mask:0xf bank_mask:0xf
    v_max3_f32 v32, v16, v17, v18
    v_max3_f32 v33, v19, v20, v21
    v_cvt_pk_bf16_f32 v23, v22, v23
    v_lshlrev_b32 v22, 16, v23
    v_and_b32 v23, 0xffff0000, v23
    v_mul_f32 v22, s61, v22
    v_mul_f32 v23, s61, v23
    v_cvt_pk_bf16_f32 v23, v22, v23
    v_lshlrev_b32 v22, 16, v23
    v_and_b32 v23, 0xffff0000, v23
    v_max3_f32 v32, v32, v33, v22
    v_max_f32 v32, v32, v23
    s_nop 1
    v_max_f32_dpp v32, v32, v32 row_half_mirror row_mask:0xf bank_mask:0xf
    v_mov_b32 v33, v32
    s_nop 1
    v_permlane16_swap_b32 v33, v32
    v_max_f32 v32, v32, v33
    v_mov_b32 v33, v32
    s_nop 1
    v_permlane32_swap_b32 v33, v32
    v_max_f32 v32, v32, v33
    s_mov_b32 s61, 0x3fb8aa3b
    v_mul_f32 v32, s61, v32
    v_fma_f32 v16, v16, s61, -v32
    v_fma_f32 v17, v17, s61, -v32
    s_waitcnt vmcnt(5)
    buffer_load_dwordx4 v[156:159], v3, s[32:35], s53 offen nt
    v_fma_f32 v18, v18, s61, -v32
    v_fma_f32 v19, v19, s61, -v32
    v_fma_f32 v20, v20, s61, -v32
    v_fma_f32 v21, v21, s61, -v32
    v_fma_f32 v22, v22, s61, -v32
    v_fma_f32 v23, v23, s61, -v32
    v_exp_f32 v16, v16
    v_exp_f32 v17, v17
    v_exp_f32 v18, v18
    v_exp_f32 v19, v19
    v_exp_f32 v20, v20
    v_exp_f32 v21, v21
    v_exp_f32 v22, v22
    v_exp_f32 v23, v23
    v_add_f32 v33, v16, v17
    v_add_f32 v34, v18, v19
    v_add_f32 v33, v33, v20
    v_add_f32 v34, v34, v21
    v_add_f32 v33, v33, v22
    v_add_f32 v34, v34, v23
    v_add_f32 v33, v33, v34
    v_cvt_pk_bf16_f32 v16, v16, v16
    v_cvt_pk_bf16_f32 v17, v17, v17
    v_add_f32_dpp v33, v33, v33 row_half_mirror row_mask:0xf bank_mask:0xf
    v_mov_b32 v34, v33
    v_cvt_pk_bf16_f32 v18, v18, v18
    v_cvt_pk_bf16_f32 v19, v19, v19
    v_permlane16_swap_b32 v34, v33
    v_add_f32 v33, v33, v34
    v_mov_b32 v34, v33
    v_cvt_pk_bf16_f32 v20, v20, v20
    v_cvt_pk_bf16_f32 v21, v21, v21
    v_permlane32_swap_b32 v34, v33
    v_add_f32 v33, v33, v34
    s_mov_b64 exec, 0x101
    ds_write_b32 v36, v32 offset:6400
    ds_write_b32 v36, v33 offset:6432
    s_mov_b64 exec, 1
    ds_add_u32 v38, v39 offset:6464
    s_mov_b64 exec, -1
    s_waitcnt vmcnt(5)
    buffer_load_dwordx4 v[160:163], v3, s[32:35], s54 offen nt
    v_cvt_pk_bf16_f32 v22, v22, v22
    v_cvt_pk_bf16_f32 v23, v23, v23
    v_and_b32 v40, v16, v4
    v_and_b32 v41, v16, v5
    v_and_b32_dpp v42, v16, v6 row_shr:4 row_mask:0xf bank_mask:0xf bound_ctrl:0
    v_and_b32_dpp v43, v16, v7 row_shr:4 row_mask:0xf bank_mask:0xf bound_ctrl:0
    v_and_b32_dpp v44, v16, v4 row_shl:4 row_mask:0xf bank_mask:0xf bound_ctrl:0
    v_and_b32_dpp v45, v16, v5 row_shl:4 row_mask:0xf bank_mask:0xf bound_ctrl:0
L_pad2:
    s_cbranch_execz L_ret3
    v_and_b32 v46, v16, v6
    v_and_b32 v47, v16, v7
    v_and_b32 v48, v17, v4
    v_and_b32 v49, v17, v5
    v_and_b32_dpp v50, v17, v6 row_shr:4 row_mask:0xf bank_mask:0xf bound_ctrl:0
    v_and_b32_dpp v51, v17, v7 row_shr:4 row_mask:0xf bank_mask:0xf bound_ctrl:0
    v_and_b32_dpp v52, v17, v4 row_shl:4 row_mask:0xf bank_mask:0xf bound_ctrl:0
    v_and_b32_dpp v53, v17, v5 row_shl:4 row_mask:0xf bank_mask:0xf bound_ctrl:0
    v_and_b32 v54, v17, v6
    v_and_b32 v55, v17, v7
    v_and_b32 v56, v18, v4
    v_and_b32 v57, v18, v5
    v_and_b32_dpp v58, v18, v6 row_shr:4 row_mask:0xf bank_mask:0xf bound_ctrl:0
    v_and_b32_dpp v59, v18, v7 row_shr:4 row_mask:0xf bank_mask:0xf bound_ctrl:0
    v_and_b32_dpp v60, v18, v4 row_shl:4 row_mask:0xf bank_mask:0xf bound_ctrl:0
    v_and_b32_dpp v61, v18, v5 row_shl:4 row_mask:0xf bank_mask:0xf bound_ctrl:0
    v_and_b32 v62, v18, v6
    v_and_b32 v63, v18, v7
    v_and_b32 v64, v19, v4
    v_and_b32 v65, v19, v5
    v_and_b32_dpp v66, v19, v6 row_shr:4 row_mask:0xf bank_mask:0xf bound_ctrl:0
    v_and_b32_dpp v67, v19, v7 row_shr:4 row_mask:0xf bank_mask:0xf bound_ctrl:0
    s_waitcnt vmcnt(5)
    buffer_load_dwordx4 v[164:167], v3, s[32:35], s55 offen nt
    s_mov_b64 exec, 1
    ds_add_u32 v38, v39 offset:6484
    s_mov_b64 exec, -1
    v_and_b32_dpp v68, v19, v4 row_shl:4 row_mask:0xf bank_mask:0xf bound_ctrl:0
    v_and_b32_dpp v69, v19, v5 row_shl:4 row_mask:0xf bank_mask:0xf bound_ctrl:0
    v_and_b32 v70, v19, v6
    v_and_b32 v71, v19, v7
    v_and_b32 v72, v20, v4
    v_and_b32 v73, v20, v5
    v_and_b32_dpp v74, v20, v6 row_shr:4 row_mask:0xf bank_mask:0xf bound_ctrl:0
    v_and_b32_dpp v75, v20, v7 row_shr:4 row_mask:0xf bank_mask:0xf bound_ctrl:0
    v_and_b32_dpp v76, v20, v4 row_shl:4 row_mask:0xf bank_mask:0xf bound_ctrl:0
    v_and_b32_dpp v77, v20, v5 row_shl:4 row_mask:0xf bank_mask:0xf bound_ctrl:0
    v_and_b32 v78, v20, v6
    v_and_b32 v79, v20, v7
    v_and_b32 v80, v21, v4
    v_and_b32 v81, v21, v5
    v_and_b32_dpp v82, v21, v6 row_shr:4 row_mask:0xf bank_mask:0xf bound_ctrl:0
    v_and_b32_dpp v83, v21, v7 row_shr:4 row_mask:0xf bank_mask:0xf bound_ctrl:0
    v_and_b32_dpp v84, v21, v4 row_shl:4 row_mask:0xf bank_mask:0xf bound_ctrl:0
    v_and_b32_dpp v85, v21, v5 row_shl:4 row_mask:0xf bank_mask:0xf bound_ctrl:0
    v_and_b32 v86, v21, v6
    v_and_b32 v87, v21, v7
    v_and_b32 v88, v22, v4
    v_and_b32 v89, v22, v5
    v_and_b32_dpp v90, v22, v6 row_shr:4 row_mask:0xf bank_mask:0xf bound_ctrl:0
    v_and_b32_dpp v91, v22, v7 row_shr:4 row_mask:0xf bank_mask:0xf bound_ctrl:0
    v_and_b32_dpp v92, v22, v4 row_shl:4 row_mask:0xf bank_mask:0xf bound_ctrl:0
    v_and_b32_dpp v93, v22, v5 row_shl:4 row_mask:0xf bank_mask:0xf bound_ctrl:0
    v_and_b32 v94, v22, v6
    v_and_b32 v95, v22, v7
    v_and_b32 v96, v23, v4
    v_and_b32 v97, v23, v5
    v_and_b32_dpp v98, v23, v6 row_shr:4 row_mask:0xf bank_mask:0xf bound_ctrl:0
    v_and_b32_dpp v99, v23, v7 row_shr:4 row_mask:0xf bank_mask:0xf bound_ctrl:0
    v_and_b32_dpp v100, v23, v4 row_shl:4 row_mask:0xf bank_mask:0xf bound_ctrl:0
    v_and_b32_dpp v101, v23, v5 row_shl:4 row_mask:0xf bank_mask:0xf bound_ctrl:0
    v_and_b32 v102, v23, v6
    v_and_b32 v103, v23, v7
    v_mfma_f32_16x16x32_bf16 v[12:15], v[40:43], v[104:107], 0
    v_mfma_f32_16x16x32_bf16 v[12:15], v[44:47], v[108:111], v[12:15]
    v_mfma_f32_16x16x32_bf16 v[12:15], v[48:51], v[112:115], v[12:15]
    v_mfma_f32_16x16x32_bf16 v[12:15], v[52:55], v[116:119], v[12:15]
    v_mfma_f32_16x16x32_bf16 v[12:15], v[56:59], v[120:123], v[12:15]
    v_mfma_f32_16x16x32_bf16 v[12:15], v[60:63], v[124:127], v[12:15]
    v_mfma_f32_16x16x32_bf16 v[12:15], v[64:67], v[128:131], v[12:15]
    v_mfma_f32_16x16x32_bf16 v[12:15], v[68:71], v[132:135], v[12:15]
    v_mfma_f32_16x16x32_bf16 v[12:15], v[72:75], v[136:139], v[12:15]
    v_mfma_f32_16x16x32_bf16 v[12:15], v[76:79], v[140:143], v[12:15]
    s_mov_b32 s62, 0
L_aw27:
    s_add_u32 s62, s62, 1
    s_cmp_ge_u32 s62, 1000000
    s_cbranch_scc1 L_fail
    ds_read_b32 v32, v38 offset:6464
    ds_read_b128 v[16:19], v37 offset:6400
    ds_read_b128 v[20:23], v37 offset:6432
    ds_read_b32 v24, v28 offset:6400
    s_waitcnt lgkmcnt(0)
    v_readfirstlane_b32 s60, v32
    s_nop 0
    s_cmp_ge_u32 s60, 4
    s_cbranch_scc0 L_aw27
    v_max3_f32 v25, v16, v17, v18
    v_max_f32 v25, v25, v19
    v_sub_f32 v16, v16, v25
    v_sub_f32 v17, v17, v25
    v_sub_f32 v18, v18, v25
    v_sub_f32 v19, v19, v25
    v_sub_f32 v24, v24, v25
    v_exp_f32 v16, v16
    v_exp_f32 v17, v17
    v_exp_f32 v18, v18
    v_exp_f32 v19, v19
    v_exp_f32 v24, v24
    v_mul_f32 v26, v16, v20
    v_fmac_f32 v26, v17, v21
    v_fmac_f32 v26, v18, v22
    v_fmac_f32 v26, v19, v23
    v_rcp_f32 v27, v26
    v_log_f32 v26, v26
    s_lshl_b32 s60, s3, 10
    v_add_u32 v36, s60, v3
    v_mul_f32 v24, v24, v27
    v_add_f32 v10, v25, v26
    v_mov_b32 v11, s58
    v_lshrrev_b32 v37, 5, v1
    v_and_b32 v35, 31, v1
    v_lshlrev_b32 v35, 4, v35
    v_lshl_add_u32 v35, v37, 11, v35
    s_lshl_b32 s60, s63, 12
    s_lshl_b32 s61, s64, 9
    s_add_u32 s60, s60, s61
    s_add_u32 s65, s60, 2686976
    s_add_u32 s50, s60, 589824
    v_and_b32 v33, 15, v1
    v_lshlrev_b32 v33, 4, v33
    v_bfe_u32 v37, v1, 4, 1
    v_lshl_add_u32 v33, v37, 3, v33
    v_lshrrev_b32 v37, 5, v1
    v_lshl_add_u32 v33, v37, 2, v33
    s_mul_i32 s61, s3, 288
    v_add_u32 v33, s61, v33
    s_add_u32 s56, s69, 2
    s_and_b32 s56, s56, 7
    s_lshl_b32 s56, s56, 2
    s_lshr_b32 s61, s69, 3
    s_add_u32 s56, s56, s61
    s_sub_u32 s56, s56, 8
    s_mul_i32 s60, s56, 0x5556
    s_bfe_u32 s60, s60, 0x20010
    s_lshl_b32 s61, s68, 2
    s_add_u32 s60, s60, s61
    s_lshl_b32 s61, s3, 5
    s_add_u32 s60, s60, s61
    s_lshl_b32 s60, s60, 11
    s_add_u32 s63, s60, 589824
    s_add_u32 s64, s63, 2097152
    s_waitcnt vmcnt(5)
    v_mfma_f32_16x16x32_bf16 v[12:15], v[80:83], v[144:147], v[12:15]
    s_waitcnt vmcnt(4)
    v_mfma_f32_16x16x32_bf16 v[12:15], v[84:87], v[148:151], v[12:15]
    s_waitcnt vmcnt(3)
    v_mfma_f32_16x16x32_bf16 v[12:15], v[88:91], v[152:155], v[12:15]
    s_waitcnt vmcnt(2)
    v_mfma_f32_16x16x32_bf16 v[12:15], v[92:95], v[156:159], v[12:15]
    s_waitcnt vmcnt(1)
    v_mfma_f32_16x16x32_bf16 v[12:15], v[96:99], v[160:163], v[12:15]
    s_waitcnt vmcnt(0)
    v_mfma_f32_16x16x32_bf16 v[12:15], v[100:103], v[164:167], v[12:15]
    s_nop 7
    v_mul_f32 v12, v12, v24
    v_mul_f32 v13, v13, v24
    v_mul_f32 v14, v14, v24
    v_mul_f32 v15, v15, v24
    ds_write_b128 v36, v[12:15] offset:6528
    s_mov_b64 exec, 1
    ds_add_rtn_u32 v32, v38, v39 offset:6468
    s_mov_b64 exec, -1
    ds_read_b128 v[16:19], v3 offset:6528
    ds_read_b128 v[20:23], v3 offset:7552
    ds_read_b128 v[24:27], v3 offset:8576
    ds_read_b128 v[28:31], v3 offset:9600
    s_waitcnt lgkmcnt(0)
    v_readfirstlane_b32 s51, v32
    v_add_f32 v16, v16, v20
    v_add_f32 v24, v24, v28
    v_add_f32 v17, v17, v21
    v_add_f32 v25, v25, v29
    v_add_f32 v18, v18, v22
    v_add_f32 v26, v26, v30
    v_add_f32 v19, v19, v23
    v_add_f32 v27, v27, v31
    s_cmp_eq_u32 s51, 3
    v_add_f32 v16, v16, v24
    v_add_f32 v17, v17, v25
    v_add_f32 v18, v18, v26
    v_add_f32 v19, v19, v27
    v_cvt_pk_bf16_f32 v8, v16, v17
    v_cvt_pk_bf16_f32 v9, v18, v19
    s_cbranch_scc0 L_kv_nopub
    buffer_store_dwordx4 v[8:11], v35, s[36:39], s65 offen
    s_cmp_eq_u32 s59, 1
    s_cbranch_scc1 L_kv_nofar
    v_mov_b32 v12, v8
    v_mov_b32 v13, v9
    v_mov_b32 v14, v10
    v_mov_b32 v15, s27
    buffer_store_dwordx4 v[12:15], v35, s[36:39], s50 offen sc1
L_kv_nofar:
L_kv_nopub:
    s_cmp_lt_u32 s56, 12
    s_cbranch_scc0 L_kv_end
    s_barrier
    s_mov_b32 s62, 0
L_h228:
    s_add_u32 s62, s62, 1
L_pad3:
    s_cbranch_execz L_ret1
    s_cmp_ge_u32 s62, 1000000
    s_cbranch_scc1 L_fail
    s_and_b32 s61, s62, s59
    s_bitcmp1_b32 s61, 1
    s_cselect_b32 s60, s63, s64
    s_cselect_b32 s57, s27, s58
    buffer_load_dwordx4 v[16:19], v3, s[36:39], s60 offen sc1
    buffer_load_dwordx4 v[20:23], v3, s[36:39], s60 offen offset:1024 sc1
    s_waitcnt vmcnt(0)
    v_cmp_ne_u32 vcc, s57, v19
    v_cmp_ne_u32 s[66:67], s57, v23
    v_max_f32 v24, v18, v22
    v_mov_b32 v25, v24
    s_or_b64 vcc, vcc, s[66:67]
    s_cbranch_scc1 L_h228
    v_permlane32_swap_b32 v25, v24
    v_max_f32 v24, v24, v25
    v_sub_f32 v18, v18, v24
    v_sub_f32 v22, v22, v24
    v_exp_f32 v18, v18
    v_exp_f32 v22, v22
    v_lshlrev_b32 v28, 16, v16
    v_and_b32 v29, 0xffff0000, v16
    v_add_f32 v24, v18, v22
    v_mov_b32 v25, v24
    v_lshlrev_b32 v30, 16, v17
    v_and_b32 v31, 0xffff0000, v17
    v_permlane32_swap_b32 v25, v24
    v_add_f32 v24, v24, v25
    v_rcp_f32 v24, v24
    v_mul_f32 v28, v28, v18
    v_mul_f32 v29, v29, v18
    v_mul_f32 v30, v30, v18
    v_mul_f32 v31, v31, v18
    v_lshlrev_b32 v16, 16, v20
    v_and_b32 v17, 0xffff0000, v20
    v_lshlrev_b32 v19, 16, v21
    v_and_b32 v20, 0xffff0000, v21
    v_fmac_f32 v28, v16, v22
    v_fmac_f32 v30, v19, v22
    v_fmac_f32 v29, v17, v22
    v_fmac_f32 v31, v20, v22
    v_permlane32_swap_b32 v28, v30
    s_nop 0
    v_permlane32_swap_b32 v29, v31
    v_add_f32 v28, v28, v30
    v_add_f32 v29, v29, v31
    v_mul_f32 v28, v28, v24
    v_mul_f32 v29, v29, v24
    v_cvt_pk_bf16_f32 v28, v28, v29
    ds_write_b32 v33, v28 offset:5248
    s_waitcnt lgkmcnt(0)
    s_barrier
L_kv_end:
    s_endpgm
L_w_ln:
    v_mov_b32 v16, 0
    v_mov_b32 v17, 0
    v_lshrrev_b32 v5, 3, v1
    v_bfe_u32 v6, v1, 1, 2
    v_bfe_u32 v7, v1, 4, 2
    v_xor_b32 v6, v6, v7
    v_lshlrev_b32 v6, 5, v6
    v_and_b32 v7, 1, v1
    v_lshl_add_u32 v6, v7, 4, v6
    s_lshl_b32 s63, s68, 1
    s_and_b32 s61, s69, 1
    s_add_u32 s63, s63, s61
    s_lshl_b32 s63, s63, 2
    s_bfe_u32 s61, s69, 0x20001
    s_add_u32 s63, s63, s61
    s_lshr_b32 s64, s69, 3
    s_mul_i32 s60, s3, 1184
    s_add_u32 s60, s60, 0
    v_add_u32 v18, s60, v2
    s_mov_b32 exec_hi, 15
    s_waitcnt vmcnt(0)
    v_lshlrev_b32 v112, 16, v104
    v_and_b32 v113, 0xffff0000, v104
    v_lshlrev_b32 v114, 16, v105
    v_and_b32 v115, 0xffff0000, v105
    v_lshlrev_b32 v116, 16, v106
    v_and_b32 v117, 0xffff0000, v106
    v_lshlrev_b32 v118, 16, v107
    v_and_b32 v119, 0xffff0000, v107
    v_lshlrev_b32 v120, 16, v108
    v_and_b32 v121, 0xffff0000, v108
    v_lshlrev_b32 v122, 16, v109
    v_and_b32 v123, 0xffff0000, v109
    v_lshlrev_b32 v124, 16, v110
    v_and_b32 v125, 0xffff0000, v110
    v_lshlrev_b32 v126, 16, v111
    v_and_b32 v127, 0xffff0000, v111
    v_add_f32 v16, v112, v113
    v_add_f32 v19, v114, v115
    v_add_f32 v16, v16, v116
    v_add_f32 v19, v19, v117
    v_add_f32 v16, v16, v118
    v_add_f32 v19, v19, v119
    v_add_f32 v16, v16, v120
    v_add_f32 v19, v19, v121
    v_add_f32 v16, v16, v122
    v_add_f32 v19, v19, v123
    v_add_f32 v16, v16, v124
    v_add_f32 v19, v19, v125
    v_add_f32 v16, v16, v126
    v_add_f32 v19, v19, v127
    v_add_f32 v16, v16, v19
    s_mov_b32 exec_hi, -1
    s_nop 0
    v_add_f32_dpp v16, v16, v16 quad_perm:[1,0,3,2] row_mask:0xf bank_mask:0xf
    s_nop 1
    v_add_f32_dpp v16, v16, v16 quad_perm:[2,3,0,1] row_mask:0xf bank_mask:0xf
    s_nop 1
    v_add_f32_dpp v16, v16, v16 row_half_mirror row_mask:0xf bank_mask:0xf
    s_nop 1
    v_add_f32_dpp v16, v16, v16 row_mirror row_mask:0xf bank_mask:0xf
    v_mov_b32 v19, v16
    s_nop 1
    v_permlane16_swap_b32 v19, v16
    v_add_f32 v16, v16, v19
    v_mov_b32 v19, v16
    s_nop 1
    v_permlane32_swap_b32 v19, v16
    v_add_f32 v16, v16, v19
    v_mul_f32 v16, 0x3ae38e39, v16
    s_mov_b32 exec_hi, 15
    v_sub_f32 v128, v112, v16
    v_sub_f32 v129, v113, v16
    v_sub_f32 v130, v114, v16
    v_sub_f32 v131, v115, v16
    v_sub_f32 v132, v116, v16
    v_sub_f32 v133, v117, v16
    v_sub_f32 v134, v118, v16
    v_sub_f32 v135, v119, v16
    v_sub_f32 v136, v120, v16
    v_sub_f32 v137, v121, v16
    v_sub_f32 v138, v122, v16
    v_sub_f32 v139, v123, v16
    v_sub_f32 v140, v124, v16
    v_sub_f32 v141, v125, v16
    v_sub_f32 v142, v126, v16
    v_sub_f32 v143, v127, v16
    v_mul_f32 v19, v128, v128
    v_fmac_f32 v17, v129, v129
    v_fmac_f32 v19, v130, v130
    v_fmac_f32 v17, v131, v131
    v_fmac_f32 v19, v132, v132
    v_fmac_f32 v17, v133, v133
    v_fmac_f32 v19, v134, v134
    v_fmac_f32 v17, v135, v135
    v_fmac_f32 v19, v136, v136
    v_fmac_f32 v17, v137, v137
    v_fmac_f32 v19, v138, v138
    v_fmac_f32 v17, v139, v139
    v_fmac_f32 v19, v140, v140
    v_fmac_f32 v17, v141, v141
    v_fmac_f32 v19, v142, v142
    v_fmac_f32 v17, v143, v143
    v_add_f32 v17, v17, v19
    s_mov_b32 exec_hi, -1
    s_nop 0
    v_add_f32_dpp v17, v17, v17 quad_perm:[1,0,3,2] row_mask:0xf bank_mask:0xf
    s_nop 1
    v_add_f32_dpp v17, v17, v17 quad_perm:[2,3,0,1] row_mask:0xf bank_mask:0xf
    s_nop 1
    v_add_f32_dpp v17, v17, v17 row_half_mirror row_mask:0xf bank_mask:0xf
    s_nop 1
    v_add_f32_dpp v17, v17, v17 row_mirror row_mask:0xf bank_mask:0xf
    v_mov_b32 v19, v17
    s_nop 1
    v_permlane16_swap_b32 v19, v17
    v_add_f32 v17, v17, v19
    v_mov_b32 v19, v17
    s_nop 1
    v_permlane32_swap_b32 v19, v17
    v_add_f32 v17, v17, v19
    v_mul_f32 v17, 0x3ae38e39, v17
    v_cvt_pk_bf16_f32 v16, v16, v17
    v_and_b32 v17, 0xffff0000, v16
    v_lshlrev_b32 v16, 16, v16
    v_add_f32 v17, 0x3727c5ac, v17
    v_cvt_pk_bf16_f32 v17, v17, v17
    v_and_b32 v17, 0xffff0000, v17
    v_sqrt_f32 v17, v17
    s_nop 0
    v_cvt_pk_bf16_f32 v17, v17, v17
    v_and_b32 v17, 0xffff0000, v17
    v_rcp_f32 v17, v17
    s_mov_b32 exec_hi, 15
    v_sub_f32 v112, v112, v16
    v_sub_f32 v113, v113, v16
    v_sub_f32 v114, v114, v16
    v_sub_f32 v115, v115, v16
    v_sub_f32 v116, v116, v16
    v_sub_f32 v117, v117, v16
    v_sub_f32 v118, v118, v16
    v_sub_f32 v119, v119, v16
    v_sub_f32 v120, v120, v16
    v_sub_f32 v121, v121, v16
    v_sub_f32 v122, v122, v16
    v_sub_f32 v123, v123, v16
    v_sub_f32 v124, v124, v16
    v_sub_f32 v125, v125, v16
    v_sub_f32 v126, v126, v16
    v_sub_f32 v127, v127, v16
    v_cvt_pk_bf16_f32 v128, v112, v113
    v_cvt_pk_bf16_f32 v129, v114, v115
    v_cvt_pk_bf16_f32 v130, v116, v117
    v_cvt_pk_bf16_f32 v131, v118, v119
    v_cvt_pk_bf16_f32 v132, v120, v121
    v_cvt_pk_bf16_f32 v133, v122, v123
    v_cvt_pk_bf16_f32 v134, v124, v125
    v_cvt_pk_bf16_f32 v135, v126, v127
    v_lshlrev_b32 v112, 16, v128
    v_and_b32 v113, 0xffff0000, v128
    v_lshlrev_b32 v114, 16, v129
    v_and_b32 v115, 0xffff0000, v129
    v_lshlrev_b32 v116, 16, v130
    v_and_b32 v117, 0xffff0000, v130
    v_lshlrev_b32 v118, 16, v131
    v_and_b32 v119, 0xffff0000, v131
L_pad4:
    s_cbranch_execz L_ret1
    v_lshlrev_b32 v120, 16, v132
    v_and_b32 v121, 0xffff0000, v132
    v_lshlrev_b32 v122, 16, v133
    v_and_b32 v123, 0xffff0000, v133
    v_lshlrev_b32 v124, 16, v134
    v_and_b32 v125, 0xffff0000, v134
    v_lshlrev_b32 v126, 16, v135
    v_and_b32 v127, 0xffff0000, v135
    v_mul_f32 v112, v112, v17
    v_mul_f32 v113, v113, v17
    v_mul_f32 v114, v114, v17
    v_mul_f32 v115, v115, v17
    v_mul_f32 v116, v116, v17
    v_mul_f32 v117, v117, v17
    v_mul_f32 v118, v118, v17
    v_mul_f32 v119, v119, v17
    v_mul_f32 v120, v120, v17
    v_mul_f32 v121, v121, v17
    v_mul_f32 v122, v122, v17
    v_mul_f32 v123, v123, v17
    v_mul_f32 v124, v124, v17
    v_mul_f32 v125, v125, v17
    v_mul_f32 v126, v126, v17
    v_mul_f32 v127, v127, v17
    v_cvt_pk_bf16_f32 v128, v112, v113
    v_cvt_pk_bf16_f32 v129, v114, v115
    v_cvt_pk_bf16_f32 v130, v116, v117
    v_cvt_pk_bf16_f32 v131, v118, v119
    v_cvt_pk_bf16_f32 v132, v120, v121
    v_cvt_pk_bf16_f32 v133, v122, v123
    v_cvt_pk_bf16_f32 v134, v124, v125
    v_cvt_pk_bf16_f32 v135, v126, v127
    s_waitcnt lgkmcnt(0)
    ds_write_b128 v18, v[128:131]
    ds_write_b128 v18, v[132:135] offset:576
    s_mov_b64 exec, 1
    ds_add_u32 v38, v39 offset:6472
    s_mov_b64 exec, -1
    s_mov_b64 exec, 0
    s_cmp_eq_u32 s3, 1
    s_cbranch_scc1 L_pad8
    s_cmp_eq_u32 s3, 2
    s_cbranch_scc1 L_pad9
    s_cmp_eq_u32 s3, 3
    s_cbranch_scc1 L_pad10
L_ret2:
    s_mov_b64 exec, -1
    s_mov_b32 s36, s24
    s_mov_b32 s37, s25
    s_mov_b32 s38, 0x400000
    s_mov_b32 s39, 0x20000
    v_lshrrev_b32 v12, 2, v1
    v_bfe_u32 v13, v1, 3, 2
    v_and_b32 v14, 3, v1
    v_lshlrev_b32 v14, 3, v14
    v_lshl_add_u32 v12, v12, 7, v14
    v_xor_b32 v14, 0, v13
    v_lshl_add_u32 v8, v14, 5, v12
    v_xor_b32 v14, 1, v13
    v_lshl_add_u32 v9, v14, 5, v12
    v_xor_b32 v14, 2, v13
    v_lshl_add_u32 v10, v14, 5, v12
    v_xor_b32 v14, 3, v13
    v_lshl_add_u32 v11, v14, 5, v12
    v_mov_b32 v15, 0xffffff00
    v_lshrrev_b32 v12, 4, v1
    v_bfe_u32 v13, v1, 2, 2
    v_and_b32 v14, 3, v1
    v_lshlrev_b32 v4, 8, v13
    v_lshl_add_u32 v4, v12, 6, v4
    v_lshl_add_u32 v4, v14, 4, v4
    s_add_u32 s27, s26, 0x6d2b79f5
    s_and_b32 s56, s27, 0xff
    s_bfe_u32 s57, s27, 0x80008
    s_bfe_u32 s58, s27, 0x80010
    s_lshr_b32 s59, s27, 24
    s_getreg_b32 s49, hwreg(HW_REG_XCC_ID)
    s_and_b32 s49, s49, 7
    s_xor_b32 s52, s56, s49
    s_xor_b32 s53, s57, s49
    s_xor_b32 s54, s58, s49
    s_xor_b32 s55, s59, s49
    s_cmp_eq_u32 s3, 3
    s_cbranch_scc1 L_W3
    s_cmp_eq_u32 s3, 0
    s_cbranch_scc0 L_P3
    s_mov_b32 s60, 1184
    v_lshlrev_b32 v2, 3, v12
    v_mad_u32_u24 v2, v13, s60, v2
    s_mul_i32 s60, s64, 288
    s_add_u32 s60, s60, 0
    v_add_u32 v2, s60, v2
    s_lshl_b32 s40, s64, 6
    s_add_u32 s40, s40, s63
    s_lshl_b32 s40, s40, 10
    s_add_u32 s40, s40, 65536
    s_mov_b32 s62, 0
L_aw29:
    s_add_u32 s62, s62, 1
    s_cmp_ge_u32 s62, 1000000
    s_cbranch_scc1 L_fail
    ds_read_b32 v33, v38 offset:6472
    s_waitcnt lgkmcnt(0)
    v_readfirstlane_b32 s60, v33
    s_nop 0
    s_cmp_ge_u32 s60, 4
    s_cbranch_scc0 L_aw29
    ds_read2_b64 v[40:43], v2 offset0:0 offset1:4
    ds_read2_b64 v[44:47], v2 offset0:8 offset1:12
    ds_read2_b64 v[48:51], v2 offset0:16 offset1:20
    ds_read2_b64 v[52:55], v2 offset0:24 offset1:28
    ds_read_b64 v[56:57], v2 offset:256
    s_mov_b32 s62, 0
L_aw30:
    s_add_u32 s62, s62, 1
    s_cmp_ge_u32 s62, 1000000
    s_cbranch_scc1 L_fail
    ds_read_b32 v33, v38 offset:6492
    s_waitcnt lgkmcnt(0)
    v_readfirstlane_b32 s60, v33
    s_nop 0
    s_cmp_ge_u32 s60, 4
    s_cbranch_scc0 L_aw30
    ds_read_b64_tr_b16 v[64:65], v8 offset:10752
    ds_read_b64_tr_b16 v[66:67], v8 offset:12800
    ds_read_b64_tr_b16 v[68:69], v9 offset:10752
    ds_read_b64_tr_b16 v[70:71], v9 offset:12800
    ds_read_b64_tr_b16 v[72:73], v10 offset:10752
    ds_read_b64_tr_b16 v[74:75], v10 offset:12800
    ds_read_b64_tr_b16 v[76:77], v11 offset:10752
    ds_read_b64_tr_b16 v[78:79], v11 offset:12800
    ds_read_b64_tr_b16 v[80:81], v8 offset:14848
    ds_read_b64_tr_b16 v[82:83], v8 offset:16896
    ds_read_b64_tr_b16 v[84:85], v9 offset:14848
    ds_read_b64_tr_b16 v[86:87], v9 offset:16896
    ds_read_b64_tr_b16 v[88:89], v10 offset:14848
    ds_read_b64_tr_b16 v[90:91], v10 offset:16896
    ds_read_b64_tr_b16 v[92:93], v11 offset:14848
    ds_read_b64_tr_b16 v[94:95], v11 offset:16896
    s_waitcnt lgkmcnt(8)
    v_mfma_f32_16x16x32_bf16 v[16:19], v[64:67], v[40:43], 0
    v_mfma_f32_16x16x32_bf16 v[20:23], v[68:71], v[40:43], 0
    v_mfma_f32_16x16x32_bf16 v[24:27], v[72:75], v[40:43], 0
    v_mfma_f32_16x16x32_bf16 v[28:31], v[76:79], v[40:43], 0
    ds_read_b64_tr_b16 v[96:97], v8 offset:18944
    ds_read_b64_tr_b16 v[98:99], v8 offset:20992
    ds_read_b64_tr_b16 v[100:101], v9 offset:18944
    ds_read_b64_tr_b16 v[102:103], v9 offset:20992
    ds_read_b64_tr_b16 v[104:105], v10 offset:18944
    ds_read_b64_tr_b16 v[106:107], v10 offset:20992
    ds_read_b64_tr_b16 v[108:109], v11 offset:18944
    ds_read_b64_tr_b16 v[110:111], v11 offset:20992
    s_waitcnt lgkmcnt(8)
    v_mfma_f32_16x16x32_bf16 v[16:19], v[80:83], v[44:47], v[16:19]
    v_mfma_f32_16x16x32_bf16 v[20:23], v[84:87], v[44:47], v[20:23]
    v_mfma_f32_16x16x32_bf16 v[24:27], v[88:91], v[44:47], v[24:27]
    v_mfma_f32_16x16x32_bf16 v[28:31], v[92:95], v[44:47], v[28:31]
    ds_read_b64_tr_b16 v[112:113], v8 offset:23040
    ds_read_b64_tr_b16 v[114:115], v8 offset:25088
    ds_read_b64_tr_b16 v[116:117], v9 offset:23040
    ds_read_b64_tr_b16 v[118:119], v9 offset:25088
    ds_read_b64_tr_b16 v[120:121], v10 offset:23040
    ds_read_b64_tr_b16 v[122:123], v10 offset:25088
    ds_read_b64_tr_b16 v[124:125], v11 offset:23040
    ds_read_b64_tr_b16 v[126:127], v11 offset:25088
    s_waitcnt lgkmcnt(8)
    v_mfma_f32_16x16x32_bf16 v[16:19], v[96:99], v[48:51], v[16:19]
    v_mfma_f32_16x16x32_bf16 v[20:23], v[100:103], v[48:51], v[20:23]
    v_mfma_f32_16x16x32_bf16 v[24:27], v[104:107], v[48:51], v[24:27]
    v_mfma_f32_16x16x32_bf16 v[28:31], v[108:111], v[48:51], v[28:31]
    ds_read_b64_tr_b16 v[128:129], v8 offset:27136
    ds_read_b64_tr_b16 v[132:133], v9 offset:27136
    ds_read_b64_tr_b16 v[136:137], v10 offset:27136
    ds_read_b64_tr_b16 v[140:141], v11 offset:27136
    s_waitcnt lgkmcnt(4)
    v_mfma_f32_16x16x32_bf16 v[16:19], v[112:115], v[52:55], v[16:19]
    v_mfma_f32_16x16x32_bf16 v[20:23], v[116:119], v[52:55], v[20:23]
    v_mfma_f32_16x16x32_bf16 v[24:27], v[120:123], v[52:55], v[24:27]
L_pad5:
    s_cbranch_execz L_ret1
    v_mfma_f32_16x16x32_bf16 v[28:31], v[124:127], v[52:55], v[28:31]
    s_waitcnt lgkmcnt(0)
    s_nop 1
    v_mfma_f32_16x16x16_bf16 v[16:19], v[128:129], v[56:57], v[16:19]
    v_mfma_f32_16x16x16_bf16 v[20:23], v[132:133], v[56:57], v[20:23]
    v_mfma_f32_16x16x16_bf16 v[24:27], v[136:137], v[56:57], v[24:27]
    v_mfma_f32_16x16x16_bf16 v[28:31], v[140:141], v[56:57], v[28:31]
    s_mov_b32 s66, 0xaaaaaaaa
    s_mov_b32 s67, 0xaaaaaaaa
    s_mov_b32 vcc_lo, 0xcccccccc
    s_mov_b32 vcc_hi, 0xcccccccc
    s_nop 1
    v_cndmask_b32 v16, v16, v20, s[66:67]
    v_cndmask_b32 v17, v17, v21, s[66:67]
    v_cndmask_b32 v18, v18, v22, s[66:67]
    v_cndmask_b32 v19, v19, v23, s[66:67]
    v_cndmask_b32 v24, v24, v28, s[66:67]
    v_cndmask_b32 v25, v25, v29, s[66:67]
    v_cndmask_b32 v26, v26, v30, s[66:67]
    v_cndmask_b32 v27, v27, v31, s[66:67]
    v_cndmask_b32 v16, v16, v24, vcc
    v_cndmask_b32 v17, v17, v25, vcc
    v_cndmask_b32 v18, v18, v26, vcc
    v_cndmask_b32 v19, v19, v27, vcc
    v_and_or_b32 v16, v16, v15, s52
    v_and_or_b32 v17, v17, v15, s53
    v_and_or_b32 v18, v18, v15, s54
    v_and_or_b32 v19, v19, v15, s55
    s_add_u32 s60, s40, 2097152
    buffer_store_dwordx4 v[16:19], v4, s[36:39], s60 offen
    s_and_b32 s60, s63, 0xfc
    s_lshl_b32 s60, s60, 10
    s_lshl_b32 s61, s64, 8
    s_add_u32 s60, s60, s61
    s_add_u32 s44, s60, 65536
    s_add_u32 s45, s44, 0x10000
    s_add_u32 s46, s44, 0x20000
    s_add_u32 s47, s44, 0x30000
    s_xor_b32 s48, s44, 0x1000
    s_add_u32 s48, s48, 2097152
    v_and_b32 v3, 15, v1
    v_lshlrev_b32 v2, 10, v12
    v_lshl_add_u32 v2, v3, 4, v2
    v_lshlrev_b32 v3, 7, v12
    v_lshl_add_u32 v3, v14, 5, v3
    v_lshl_add_u32 v3, v13, 3, v3
    v_lshlrev_b32 v34, 16, v12
    v_lshl_add_u32 v34, v13, 10, v34
    v_lshl_add_u32 v34, v14, 4, v34
    s_waitcnt vmcnt(0)
    s_mov_b32 s62, 0
L_h131:
    s_add_u32 s62, s62, 1
    s_cmp_ge_u32 s62, 1000000
    s_cbranch_scc1 L_fail
    s_cmp_eq_u32 s62, 4
    s_cbranch_scc0 L_h131n
    v_xor_b32 v20, s49, v16
    v_xor_b32 v21, s49, v17
    v_xor_b32 v22, s49, v18
    v_xor_b32 v23, s49, v19
    buffer_store_dwordx4 v[20:23], v4, s[36:39], s40 offen sc1
L_h131n:
    s_cmp_ge_u32 s62, 4
    s_cselect_b32 s61, s62, 0
    s_bitcmp1_b32 s61, 0
    s_cselect_b32 s61, 0, 2097152
    s_cselect_b32 s60, 0, s49
    v_add_u32 v33, s61, v2
    s_xor_b32 s52, s56, s60
    s_xor_b32 s53, s57, s60
    s_xor_b32 s54, s58, s60
    s_xor_b32 s55, s59, s60
    s_cmp_eq_u32 s61, 0
    s_cselect_b32 s43, s44, s48
    s_cselect_b32 s42, 2, 1
    buffer_load_dwordx4 v[64:67], v33, s[36:39], s44 offen sc1
    buffer_load_dwordx4 v[68:71], v33, s[36:39], s45 offen sc1
    buffer_load_dwordx4 v[72:75], v33, s[36:39], s46 offen sc1
    buffer_load_dwordx4 v[76:79], v33, s[36:39], s47 offen sc1
    buffer_load_dwordx4 v[80:83], v34, s[36:39], s43 offen sc1
    s_waitcnt vmcnt(0)
    v_xor_b32 v64, s52, v64
    v_xor_b32 v65, s53, v65
    v_xor_b32 v66, s54, v66
    v_xor_b32 v67, s55, v67
    v_xor_b32 v68, s52, v68
    v_xor_b32 v69, s53, v69
    v_xor_b32 v70, s54, v70
    v_xor_b32 v71, s55, v71
    v_xor_b32 v72, s52, v72
    v_xor_b32 v73, s53, v73
    v_xor_b32 v74, s54, v74
    v_xor_b32 v75, s55, v75
    v_xor_b32 v76, s52, v76
    v_xor_b32 v77, s53, v77
    v_xor_b32 v78, s54, v78
    v_xor_b32 v79, s55, v79
    v_xor_b32 v80, s52, v80
    v_xor_b32 v81, s53, v81
    v_xor_b32 v82, s54, v82
    v_xor_b32 v83, s55, v83
    v_or_b32 v32, v64, v65
    v_or3_b32 v32, v32, v66, v67
    v_or3_b32 v32, v32, v68, v69
    v_or3_b32 v32, v32, v70, v71
    v_or3_b32 v32, v32, v72, v73
    v_or3_b32 v32, v32, v74, v75
    v_or3_b32 v32, v32, v76, v77
    v_or3_b32 v32, v32, v78, v79
    v_or3_b32 v32, v32, v80, v81
    v_or3_b32 v32, v32, v82, v83
    v_and_b32 v32, 0xff, v32
    v_cmp_ne_u32 vcc, 0, v32
    s_nop 4
    s_cbranch_vccnz L_h131
    v_add_f32 v64, v64, v68
    v_add_f32 v72, v72, v76
    v_add_f32 v65, v65, v69
    v_add_f32 v73, v73, v77
    v_add_f32 v66, v66, v70
    v_add_f32 v74, v74, v78
    v_add_f32 v67, v67, v71
    v_add_f32 v75, v75, v79
    v_add_f32 v64, v64, v72
    v_add_f32 v65, v65, v73
    v_add_f32 v66, v66, v74
    v_add_f32 v67, v67, v75
    v_cvt_pk_bf16_f32 v64, v64, v65
    v_cvt_pk_bf16_f32 v65, v66, v67
    v_mov_b32 v33, s42
    ds_write_b64 v3, v[64:65] offset:4736
    s_mov_b64 exec, 1
    ds_add_u32 v38, v33 offset:6480
    s_mov_b64 exec, -1
L_P3:
    s_mul_i32 s65, s3, 18432
    s_add_u32 s65, s65, 53760
    s_mov_b32 s60, 1152
    v_mad_u32_u24 v2, v5, s60, v6
    v_add_u32 v8, s65, v8
    v_add_u32 v9, s65, v9
    v_add_u32 v10, s65, v10
    v_add_u32 v11, s65, v11
    v_mul_u32_u24 v7, 288, v14
    v_lshl_add_u32 v3, v12, 3, v7
    v_add_u32 v3, 5248, v3
L_pad6:
    s_cbranch_execz L_ret1
    s_mov_b32 m0, s65
    s_setprio 0
    v_cmp_eq_u32 vcc, 0, v13
    s_nop 1
    v_cndmask_b32 v34, 0, v15, vcc
    v_cmp_eq_u32 vcc, 1, v13
    s_nop 1
    v_cndmask_b32 v35, 0, v15, vcc
    v_cmp_eq_u32 vcc, 2, v13
    s_nop 1
    v_cndmask_b32 v36, 0, v15, vcc
    v_cmp_eq_u32 vcc, 3, v13
    s_nop 1
    v_cndmask_b32 v37, 0, v15, vcc
    s_add_u32 s40, s69, 2
    s_and_b32 s40, s40, 7
    s_lshl_b32 s40, s40, 2
    s_lshr_b32 s61, s69, 3
    s_add_u32 s40, s40, s61
    s_lshl_b32 s60, s3, 2
    s_xor_b32 s60, s60, 8
    s_add_u32 s60, s60, s40
    s_add_u32 s63, s40, 20
    s_cmp_lt_u32 s60, 4
    s_cbranch_scc1 L_RED
    s_cmp_lt_u32 s40, 8
    s_cbranch_scc1 L_idle
    s_sub_u32 s40, s40, 8
    s_mul_i32 s63, s40, 0x5556
    s_lshr_b32 s63, s63, 16
    s_mul_i32 s64, s63, 3
    s_sub_u32 s64, s40, s64
    s_mul_i32 s64, s64, 3
    s_add_u32 s64, s64, s3
    s_and_b32 s63, s63, 3
    s_lshl_b32 s61, s68, 2
    s_add_u32 s63, s63, s61
    s_cmp_ge_u32 s40, 12
    s_cbranch_scc1 L_P3_w2
    s_mul_i32 s41, s63, 128
    s_lshl_b32 s60, s64, 16
    s_add_u32 s41, s41, 851968
    s_lshl_b32 s61, s64, 7
    s_mul_i32 s40, s63, 147456
    s_add_u32 s40, s40, s61
    s_mov_b32 s28, s12
    s_mov_b32 s29, s13
    s_mov_b32 s30, 0x480000
    s_mov_b32 s31, 0x20000
    s_lshl_b32 s60, s64, 3
    v_lshrrev_b32 v33, 7, v4
    v_and_b32 v4, 0x7f, v4
    v_add_u32 v33, s60, v33
    v_lshlrev_b32 v33, 1, v33
    v_subrev_u32 v32, 71, v33
    v_cmp_le_u32 vcc, 72, v33
    s_nop 1
    v_cndmask_b32 v33, v33, v32, vcc
    v_xor_b32 v33, 0, v33
    v_lshl_add_u32 v4, v33, 13, v4
    s_mov_b32 s62, 0
L_aw32:
    s_add_u32 s62, s62, 1
    s_cmp_ge_u32 s62, 1000000
    s_cbranch_scc1 L_fail
    s_sleep 1
    ds_read_b32 v32, v38 offset:6484
    s_waitcnt lgkmcnt(0)
    v_readfirstlane_b32 s60, v32
    s_nop 0
    s_cmp_ge_u32 s60, 4
    s_cbranch_scc0 L_aw32
    s_mov_b32 s62, 9
L_dma33:
    buffer_load_dwordx4 v2, s[28:31], s40 offen nt lds
    s_add_u32 m0, m0, 0x400
    s_add_u32 s40, s40, 0x2400
    s_sub_u32 s62, s62, 1
    s_cmp_lg_u32 s62, 0
    s_cbranch_scc1 L_dma33
    s_mov_b32 s62, 7
L_dma34:
    s_waitcnt vmcnt(8)
    buffer_load_dwordx4 v2, s[28:31], s40 offen nt lds
    s_add_u32 m0, m0, 0x400
    s_add_u32 s40, s40, 0x2400
    s_sub_u32 s62, s62, 1
    s_cmp_lg_u32 s62, 0
    s_cbranch_scc1 L_dma34
    s_waitcnt vmcnt(12)
    s_barrier
    ds_read_b64_tr_b16 v[64:65], v8 offset:0
    ds_read_b64_tr_b16 v[66:67], v8 offset:2048
    ds_read_b64_tr_b16 v[68:69], v9 offset:0
    ds_read_b64_tr_b16 v[70:71], v9 offset:2048
    ds_read_b64_tr_b16 v[72:73], v10 offset:0
    ds_read_b64_tr_b16 v[74:75], v10 offset:2048
    ds_read_b64_tr_b16 v[76:77], v11 offset:0
    ds_read_b64_tr_b16 v[78:79], v11 offset:2048
    s_waitcnt vmcnt(8)
    ds_read_b64_tr_b16 v[80:81], v8 offset:4096
    ds_read_b64_tr_b16 v[82:83], v8 offset:6144
    ds_read_b64_tr_b16 v[84:85], v9 offset:4096
    ds_read_b64_tr_b16 v[86:87], v9 offset:6144
    ds_read_b64_tr_b16 v[88:89], v10 offset:4096
    ds_read_b64_tr_b16 v[90:91], v10 offset:6144
    ds_read_b64_tr_b16 v[92:93], v11 offset:4096
    ds_read_b64_tr_b16 v[94:95], v11 offset:6144
    s_waitcnt vmcnt(4)
    ds_read_b64_tr_b16 v[96:97], v8 offset:8192
    ds_read_b64_tr_b16 v[98:99], v8 offset:10240
    ds_read_b64_tr_b16 v[100:101], v9 offset:8192
    ds_read_b64_tr_b16 v[102:103], v9 offset:10240
    ds_read_b64_tr_b16 v[104:105], v10 offset:8192
    ds_read_b64_tr_b16 v[106:107], v10 offset:10240
    ds_read_b64_tr_b16 v[108:109], v11 offset:8192
    ds_read_b64_tr_b16 v[110:111], v11 offset:10240
    s_waitcnt vmcnt(0)
    ds_read_b64_tr_b16 v[112:113], v8 offset:12288
    ds_read_b64_tr_b16 v[114:115], v8 offset:14336
    ds_read_b64_tr_b16 v[116:117], v9 offset:12288
    ds_read_b64_tr_b16 v[118:119], v9 offset:14336
    ds_read_b64_tr_b16 v[120:121], v10 offset:12288
    ds_read_b64_tr_b16 v[122:123], v10 offset:14336
    ds_read_b64_tr_b16 v[124:125], v11 offset:12288
    ds_read_b64_tr_b16 v[126:127], v11 offset:14336
    s_waitcnt lgkmcnt(0)
    s_setprio 3
    s_barrier
L_wo_tail:
    ds_read2_b64 v[40:43], v3 offset0:0 offset1:4
    ds_read2_b64 v[44:47], v3 offset0:8 offset1:12
    ds_read2_b64 v[48:51], v3 offset0:16 offset1:20
    ds_read2_b64 v[52:55], v3 offset0:24 offset1:28
    s_waitcnt lgkmcnt(3)
    v_mfma_f32_16x16x32_bf16 v[16:19], v[64:67], v[40:43], 0
    v_mfma_f32_16x16x32_bf16 v[20:23], v[68:71], v[40:43], 0
    s_waitcnt lgkmcnt(2)
    v_mfma_f32_16x16x32_bf16 v[16:19], v[80:83], v[44:47], v[16:19]
    v_mfma_f32_16x16x32_bf16 v[20:23], v[84:87], v[44:47], v[20:23]
    s_waitcnt lgkmcnt(1)
    v_mfma_f32_16x16x32_bf16 v[16:19], v[96:99], v[48:51], v[16:19]
    v_mfma_f32_16x16x32_bf16 v[20:23], v[100:103], v[48:51], v[20:23]
    s_waitcnt lgkmcnt(0)
    v_mfma_f32_16x16x32_bf16 v[16:19], v[112:115], v[52:55], v[16:19]
    v_mfma_f32_16x16x32_bf16 v[20:23], v[116:119], v[52:55], v[20:23]
    v_mfma_f32_16x16x32_bf16 v[24:27], v[72:75], v[40:43], 0
    v_mfma_f32_16x16x32_bf16 v[24:27], v[88:91], v[44:47], v[24:27]
    v_mfma_f32_16x16x32_bf16 v[24:27], v[104:107], v[48:51], v[24:27]
    v_mfma_f32_16x16x32_bf16 v[24:27], v[120:123], v[52:55], v[24:27]
    v_mfma_f32_16x16x32_bf16 v[28:31], v[76:79], v[40:43], 0
    v_mfma_f32_16x16x32_bf16 v[28:31], v[92:95], v[44:47], v[28:31]
    s_nop 0
    v_and_or_b32 v60, v16, v34, s56
    v_and_or_b32 v61, v17, v34, s57
    v_and_or_b32 v62, v18, v34, s58
    v_and_or_b32 v63, v19, v34, s59
    v_mfma_f32_16x16x32_bf16 v[28:31], v[108:111], v[48:51], v[28:31]
    v_and_or_b32 v60, v20, v35, v60
    v_and_or_b32 v61, v21, v35, v61
    v_and_or_b32 v62, v22, v35, v62
    v_and_or_b32 v63, v23, v35, v63
    v_mfma_f32_16x16x32_bf16 v[28:31], v[124:127], v[52:55], v[28:31]
    v_and_or_b32 v60, v24, v36, v60
    v_and_or_b32 v61, v25, v36, v61
    v_and_or_b32 v62, v26, v36, v62
    v_and_or_b32 v63, v27, v36, v63
    s_nop 3
    v_and_or_b32 v60, v28, v37, v60
    v_and_or_b32 v61, v29, v37, v61
    v_and_or_b32 v62, v30, v37, v62
    v_and_or_b32 v63, v31, v37, v63
    buffer_store_dwordx4 v[60:63], v4, s[36:39], s41 offen sc1
    s_branch L_w_end
L_P3_w2:
    s_mul_i32 s41, s63, 128
    s_lshl_b32 s60, s64, 16
    s_add_u32 s41, s41, 856064
    s_lshl_b32 s61, s64, 7
    s_mul_i32 s40, s63, 165888
    s_add_u32 s40, s40, s61
    s_mul_i32 s42, s63, 2304
    s_mul_i32 s60, s3, 768
L_pad7:
    s_cbranch_execz L_ret3
    s_add_u32 s42, s42, s60
    s_add_u32 s42, s42, 327680
    s_add_u32 s43, s42, 73728
    s_add_u32 s44, s42, 147456
    v_lshlrev_b32 v5, 4, v1
    v_lshrrev_b32 v12, 2, v1
    v_lshl_add_u32 v7, v12, 3, v7
    s_mul_i32 s60, s3, 96
    v_add_u32 v7, s60, v7
    s_mov_b32 s28, s18
    s_mov_b32 s29, s19
    s_mov_b32 s30, 0x510000
    s_mov_b32 s31, 0x20000
    s_lshl_b32 s60, s64, 3
    v_lshrrev_b32 v33, 7, v4
    v_and_b32 v4, 0x7f, v4
    v_add_u32 v33, s60, v33
    v_lshlrev_b32 v33, 1, v33
    v_subrev_u32 v32, 71, v33
    v_cmp_le_u32 vcc, 72, v33
    s_nop 1
    v_cndmask_b32 v33, v33, v32, vcc
    v_xor_b32 v33, 0, v33
    v_lshl_add_u32 v4, v33, 13, v4
    s_mov_b32 s62, 0
L_aw35:
    s_add_u32 s62, s62, 1
    s_cmp_ge_u32 s62, 1000000
    s_cbranch_scc1 L_fail
    s_sleep 1
    ds_read_b32 v32, v38 offset:6484
    s_waitcnt lgkmcnt(0)
    v_readfirstlane_b32 s60, v32
    s_nop 0
    s_cmp_ge_u32 s60, 4
    s_cbranch_scc0 L_aw35
    s_mov_b32 exec_hi, 0xffff
    s_mov_b32 s62, 0
    s_cmp_ge_u32 s62, 4
    s_cselect_b32 s61, s62, 0
    s_bitcmp1_b32 s61, 0
    s_cselect_b32 s61, 0, 2097152
    s_cselect_b32 s60, 0, s49
    v_add_u32 v33, s61, v5
    s_xor_b32 s52, s56, s60
    s_xor_b32 s53, s57, s60
    s_xor_b32 s54, s58, s60
    s_xor_b32 s55, s59, s60
    buffer_load_dwordx4 v[16:19], v33, s[36:39], s42 offen sc1
    buffer_load_dwordx4 v[20:23], v33, s[36:39], s43 offen sc1
    buffer_load_dwordx4 v[24:27], v33, s[36:39], s44 offen sc1
    s_mov_b32 exec_hi, -1
    s_mov_b32 s62, 9
L_dma36:
    buffer_load_dwordx4 v2, s[28:31], s40 offen nt lds
    s_add_u32 m0, m0, 0x400
    s_add_u32 s40, s40, 0x2400
    s_sub_u32 s62, s62, 1
    s_cmp_lg_u32 s62, 0
    s_cbranch_scc1 L_dma36
    s_mov_b32 s62, 9
L_dma37:
    s_waitcnt vmcnt(8)
    buffer_load_dwordx4 v2, s[28:31], s40 offen nt lds
    s_add_u32 m0, m0, 0x400
    s_add_u32 s40, s40, 0x2400
    s_sub_u32 s62, s62, 1
    s_cmp_lg_u32 s62, 0
    s_cbranch_scc1 L_dma37
    s_mov_b32 exec_hi, 0xffff
    s_waitcnt vmcnt(18)
    s_branch L_hh_chk
L_hh_retry:
    s_add_u32 s62, s62, 1
    s_cmp_ge_u32 s62, 1000000
    s_cbranch_scc1 L_fail
    s_cmp_ge_u32 s62, 4
    s_cselect_b32 s61, s62, 0
    s_bitcmp1_b32 s61, 0
    s_cselect_b32 s61, 0, 2097152
    s_cselect_b32 s60, 0, s49
    v_add_u32 v33, s61, v5
    s_xor_b32 s52, s56, s60
    s_xor_b32 s53, s57, s60
    s_xor_b32 s54, s58, s60
    s_xor_b32 s55, s59, s60
    buffer_load_dwordx4 v[16:19], v33, s[36:39], s42 offen sc1
    buffer_load_dwordx4 v[20:23], v33, s[36:39], s43 offen sc1
    buffer_load_dwordx4 v[24:27], v33, s[36:39], s44 offen sc1
    s_waitcnt vmcnt(0)
L_hh_chk:
    v_xor_b32 v16, s52, v16
    v_xor_b32 v17, s53, v17
    v_xor_b32 v18, s54, v18
    v_xor_b32 v19, s55, v19
    v_xor_b32 v20, s52, v20
    v_xor_b32 v21, s53, v21
    v_xor_b32 v22, s54, v22
    v_xor_b32 v23, s55, v23
    v_xor_b32 v24, s52, v24
    v_xor_b32 v25, s53, v25
    v_xor_b32 v26, s54, v26
    v_xor_b32 v27, s55, v27
    v_or_b32 v28, v16, v17
    v_or3_b32 v28, v28, v18, v19
    v_or3_b32 v28, v28, v20, v21
    v_or3_b32 v28, v28, v22, v23
    v_or3_b32 v28, v28, v24, v25
    v_or3_b32 v28, v28, v26, v27
    v_and_b32 v28, 0xff, v28
    v_cmp_ne_u32 vcc, 0, v28
    s_nop 4
    s_cbranch_vccnz L_hh_retry
    v_add_f32 v16, v16, v20
    v_add_f32 v17, v17, v21
    v_add_f32 v18, v18, v22
    v_add_f32 v19, v19, v23
    v_add_f32 v16, v16, v24
    v_add_f32 v17, v17, v25
    v_add_f32 v18, v18, v26
    v_add_f32 v19, v19, v27
    v_cvt_pk_bf16_f32 v20, v16, v17
    v_cvt_pk_bf16_f32 v21, v18, v19
    v_lshlrev_b32 v16, 16, v20
    v_and_b32 v17, 0xffff0000, v20
    v_lshlrev_b32 v18, 16, v21
    v_and_b32 v19, 0xffff0000, v21
    v_mul_f32 v20, 0xbfb8aa3b, v16
    v_exp_f32 v20, v20
    s_nop 0
    v_add_f32 v20, 1.0, v20
    v_rcp_f32 v20, v20
    s_nop 0
    v_mul_f32 v16, v16, v20
    v_mul_f32 v21, 0xbfb8aa3b, v17
    v_exp_f32 v21, v21
    s_nop 0
    v_add_f32 v21, 1.0, v21
    v_rcp_f32 v21, v21
    s_nop 0
    v_mul_f32 v17, v17, v21
    v_mul_f32 v22, 0xbfb8aa3b, v18
    v_exp_f32 v22, v22
    s_nop 0
    v_add_f32 v22, 1.0, v22
    v_rcp_f32 v22, v22
    s_nop 0
    v_mul_f32 v18, v18, v22
    v_mul_f32 v23, 0xbfb8aa3b, v19
    v_exp_f32 v23, v23
    s_nop 0
    v_add_f32 v23, 1.0, v23
    v_rcp_f32 v23, v23
    s_nop 0
    v_mul_f32 v19, v19, v23
    v_cvt_pk_bf16_f32 v16, v16, v17
    v_cvt_pk_bf16_f32 v17, v18, v19
    ds_write_b64 v7, v[16:17] offset:5248
    s_mov_b64 exec, 1
    ds_add_u32 v38, v39 offset:6488
    s_mov_b64 exec, -1
    s_mov_b32 s62, 0
L_aw38:
    s_add_u32 s62, s62, 1
    s_cmp_ge_u32 s62, 1000000
    s_cbranch_scc1 L_fail
    ds_read_b32 v32, v38 offset:6488
    s_waitcnt lgkmcnt(0)
    v_readfirstlane_b32 s60, v32
    s_nop 0
    s_cmp_ge_u32 s60, 3
    s_cbranch_scc0 L_aw38
L_w2_tail:
    ds_read2_b64 v[40:43], v3 offset0:0 offset1:4
    ds_read2_b64 v[44:47], v3 offset0:8 offset1:12
    ds_read2_b64 v[48:51], v3 offset0:16 offset1:20
    ds_read2_b64 v[52:55], v3 offset0:24 offset1:28
    ds_read_b64 v[56:57], v3 offset:256
    s_waitcnt vmcnt(14)
    ds_read_b64_tr_b16 v[64:65], v8 offset:0
    ds_read_b64_tr_b16 v[66:67], v8 offset:2048
    ds_read_b64_tr_b16 v[68:69], v9 offset:0
    ds_read_b64_tr_b16 v[70:71], v9 offset:2048
    ds_read_b64_tr_b16 v[72:73], v10 offset:0
    ds_read_b64_tr_b16 v[74:75], v10 offset:2048
    ds_read_b64_tr_b16 v[76:77], v11 offset:0
    ds_read_b64_tr_b16 v[78:79], v11 offset:2048
    s_waitcnt vmcnt(10)
    ds_read_b64_tr_b16 v[80:81], v8 offset:4096
    ds_read_b64_tr_b16 v[82:83], v8 offset:6144
    ds_read_b64_tr_b16 v[84:85], v9 offset:4096
    ds_read_b64_tr_b16 v[86:87], v9 offset:6144
    ds_read_b64_tr_b16 v[88:89], v10 offset:4096
    ds_read_b64_tr_b16 v[90:91], v10 offset:6144
    ds_read_b64_tr_b16 v[92:93], v11 offset:4096
    ds_read_b64_tr_b16 v[94:95], v11 offset:6144
    s_waitcnt lgkmcnt(8)
    v_mfma_f32_16x16x32_bf16 v[16:19], v[64:67], v[40:43], 0
    v_mfma_f32_16x16x32_bf16 v[20:23], v[68:71], v[40:43], 0
    v_mfma_f32_16x16x32_bf16 v[24:27], v[72:75], v[40:43], 0
    v_mfma_f32_16x16x32_bf16 v[28:31], v[76:79], v[40:43], 0
    s_waitcnt vmcnt(6)
    ds_read_b64_tr_b16 v[96:97], v8 offset:8192
L_pad8:
    s_cbranch_execz L_ret2
    ds_read_b64_tr_b16 v[98:99], v8 offset:10240
    ds_read_b64_tr_b16 v[100:101], v9 offset:8192
    ds_read_b64_tr_b16 v[102:103], v9 offset:10240
    ds_read_b64_tr_b16 v[104:105], v10 offset:8192
    ds_read_b64_tr_b16 v[106:107], v10 offset:10240
    ds_read_b64_tr_b16 v[108:109], v11 offset:8192
    ds_read_b64_tr_b16 v[110:111], v11 offset:10240
    s_waitcnt lgkmcnt(8)
    v_mfma_f32_16x16x32_bf16 v[16:19], v[80:83], v[44:47], v[16:19]
    v_mfma_f32_16x16x32_bf16 v[20:23], v[84:87], v[44:47], v[20:23]
    v_mfma_f32_16x16x32_bf16 v[24:27], v[88:91], v[44:47], v[24:27]
    v_mfma_f32_16x16x32_bf16 v[28:31], v[92:95], v[44:47], v[28:31]
    s_waitcnt vmcnt(2)
    ds_read_b64_tr_b16 v[112:113], v8 offset:12288
    ds_read_b64_tr_b16 v[114:115], v8 offset:14336
    ds_read_b64_tr_b16 v[116:117], v9 offset:12288
    ds_read_b64_tr_b16 v[118:119], v9 offset:14336
    ds_read_b64_tr_b16 v[120:121], v10 offset:12288
    ds_read_b64_tr_b16 v[122:123], v10 offset:14336
    ds_read_b64_tr_b16 v[124:125], v11 offset:12288
    ds_read_b64_tr_b16 v[126:127], v11 offset:14336
    s_waitcnt lgkmcnt(8)
    v_mfma_f32_16x16x32_bf16 v[16:19], v[96:99], v[48:51], v[16:19]
    v_mfma_f32_16x16x32_bf16 v[20:23], v[100:103], v[48:51], v[20:23]
    v_mfma_f32_16x16x32_bf16 v[24:27], v[104:107], v[48:51], v[24:27]
    v_mfma_f32_16x16x32_bf16 v[28:31], v[108:111], v[48:51], v[28:31]
    s_waitcnt vmcnt(0)
    ds_read_b64_tr_b16 v[128:129], v8 offset:16384
    ds_read_b64_tr_b16 v[132:133], v9 offset:16384
    ds_read_b64_tr_b16 v[136:137], v10 offset:16384
    ds_read_b64_tr_b16 v[140:141], v11 offset:16384
    s_waitcnt lgkmcnt(4)
    v_mfma_f32_16x16x32_bf16 v[16:19], v[112:115], v[52:55], v[16:19]
    v_mfma_f32_16x16x32_bf16 v[20:23], v[116:119], v[52:55], v[20:23]
    v_mfma_f32_16x16x32_bf16 v[24:27], v[120:123], v[52:55], v[24:27]
    v_mfma_f32_16x16x32_bf16 v[28:31], v[124:127], v[52:55], v[28:31]
    s_waitcnt lgkmcnt(0)
    s_nop 1
    v_mfma_f32_16x16x16_bf16 v[16:19], v[128:129], v[56:57], v[16:19]
    v_mfma_f32_16x16x16_bf16 v[20:23], v[132:133], v[56:57], v[20:23]
    v_mfma_f32_16x16x16_bf16 v[24:27], v[136:137], v[56:57], v[24:27]
    v_mfma_f32_16x16x16_bf16 v[28:31], v[140:141], v[56:57], v[28:31]
    s_nop 4
    v_and_or_b32 v60, v16, v34, s56
    v_and_or_b32 v61, v17, v34, s57
    v_and_or_b32 v62, v18, v34, s58
    v_and_or_b32 v63, v19, v34, s59
    v_and_or_b32 v60, v20, v35, v60
    v_and_or_b32 v61, v21, v35, v61
    v_and_or_b32 v62, v22, v35, v62
    v_and_or_b32 v63, v23, v35, v63
    v_and_or_b32 v60, v24, v36, v60
    v_and_or_b32 v61, v25, v36, v61
    v_and_or_b32 v62, v26, v36, v62
    v_and_or_b32 v63, v27, v36, v63
    v_and_or_b32 v60, v28, v37, v60
    v_and_or_b32 v61, v29, v37, v61
    v_and_or_b32 v62, v30, v37, v62
    v_and_or_b32 v63, v31, v37, v63
    buffer_store_dwordx4 v[60:63], v4, s[36:39], s41 offen sc1
    s_branch L_w_end
L_idle:
    s_branch L_w_end
L_W3:
    s_add_u32 s60, s69, 2
    s_and_b32 s60, s60, 7
    s_lshl_b32 s60, s60, 2
    s_lshr_b32 s61, s69, 3
    s_add_u32 s60, s60, s61
    s_sub_u32 s61, s60, 3
    s_cmp_lt_u32 s60, 4
    s_cselect_b32 s61, s60, s61
    s_lshr_b32 s65, s61, 3
    s_and_b32 s42, s61, 7
    s_add_u32 s42, s42, 1
    s_sub_u32 s61, s60, 4
    s_cmp_lt_u32 s61, 3
    s_cselect_b32 s65, s61, s65
    s_cselect_b32 s42, 0, s42
    s_sub_u32 s61, 3, s68
    s_and_b32 s61, s61, 7
    s_add_u32 s42, s42, s61
    s_sub_u32 s61, s42, 9
    s_cmp_ge_u32 s42, 9
    s_cselect_b32 s42, s61, s42
    s_mul_i32 s61, s68, 9
    s_add_u32 s42, s42, s61
    s_cmp_ge_u32 s65, 3
    s_cbranch_scc1 L_W1_done
    s_mov_b32 s60, 1184
    v_lshlrev_b32 v2, 3, v12
    v_mad_u32_u24 v2, v14, s60, v2
    s_mul_i32 s60, s65, 384
    s_add_u32 s60, s60, 0
    v_add_u32 v2, s60, v2
    s_mul_i32 s41, s65, 72
    s_add_u32 s41, s41, s42
    s_lshl_b32 s41, s41, 10
    s_add_u32 s41, s41, 327680
    s_mov_b32 s62, 0
L_aw39:
    s_add_u32 s62, s62, 1
    s_cmp_ge_u32 s62, 1000000
    s_cbranch_scc1 L_fail
    ds_read_b32 v32, v38 offset:6472
    s_waitcnt lgkmcnt(0)
    v_readfirstlane_b32 s60, v32
    s_nop 0
    s_cmp_ge_u32 s60, 4
    s_cbranch_scc0 L_aw39
    ds_read2_b64 v[40:43], v2 offset0:0 offset1:4
    ds_read2_b64 v[44:47], v2 offset0:8 offset1:12
    ds_read2_b64 v[48:51], v2 offset0:16 offset1:20
    ds_read2_b64 v[52:55], v2 offset0:24 offset1:28
    ds_read2_b64 v[56:59], v2 offset0:32 offset1:36
    ds_read2_b64 v[60:63], v2 offset0:40 offset1:44
    s_mov_b32 s62, 0
L_aw40:
    s_add_u32 s62, s62, 1
    s_cmp_ge_u32 s62, 1000000
    s_cbranch_scc1 L_fail
    s_sleep 1
    ds_read_b32 v32, v38 offset:6476
    s_waitcnt lgkmcnt(0)
    v_readfirstlane_b32 s60, v32
    s_nop 0
    s_cmp_ge_u32 s60, 4
    s_cbranch_scc0 L_aw40
    ds_read_b64_tr_b16 v[64:65], v8 offset:29184
    ds_read_b64_tr_b16 v[66:67], v8 offset:31232
    ds_read_b64_tr_b16 v[68:69], v9 offset:29184
    ds_read_b64_tr_b16 v[70:71], v9 offset:31232
    ds_read_b64_tr_b16 v[72:73], v10 offset:29184
    ds_read_b64_tr_b16 v[74:75], v10 offset:31232
    ds_read_b64_tr_b16 v[76:77], v11 offset:29184
    ds_read_b64_tr_b16 v[78:79], v11 offset:31232
    ds_read_b64_tr_b16 v[80:81], v8 offset:33280
    ds_read_b64_tr_b16 v[82:83], v8 offset:35328
    ds_read_b64_tr_b16 v[84:85], v9 offset:33280
    ds_read_b64_tr_b16 v[86:87], v9 offset:35328
    ds_read_b64_tr_b16 v[88:89], v10 offset:33280
    ds_read_b64_tr_b16 v[90:91], v10 offset:35328
    ds_read_b64_tr_b16 v[92:93], v11 offset:33280
    ds_read_b64_tr_b16 v[94:95], v11 offset:35328
    s_waitcnt lgkmcnt(8)
    v_mfma_f32_16x16x32_bf16 v[16:19], v[64:67], v[40:43], 0
    v_mfma_f32_16x16x32_bf16 v[20:23], v[68:71], v[40:43], 0
    v_mfma_f32_16x16x32_bf16 v[24:27], v[72:75], v[40:43], 0
    v_mfma_f32_16x16x32_bf16 v[28:31], v[76:79], v[40:43], 0
    ds_read_b64_tr_b16 v[96:97], v8 offset:37376
    ds_read_b64_tr_b16 v[98:99], v8 offset:39424
    ds_read_b64_tr_b16 v[100:101], v9 offset:37376
    ds_read_b64_tr_b16 v[102:103], v9 offset:39424
    ds_read_b64_tr_b16 v[104:105], v10 offset:37376
    ds_read_b64_tr_b16 v[106:107], v10 offset:39424
    ds_read_b64_tr_b16 v[108:109], v11 offset:37376
    ds_read_b64_tr_b16 v[110:111], v11 offset:39424
    s_waitcnt lgkmcnt(8)
    v_mfma_f32_16x16x32_bf16 v[16:19], v[80:83], v[44:47], v[16:19]
    v_mfma_f32_16x16x32_bf16 v[20:23], v[84:87], v[44:47], v[20:23]
    v_mfma_f32_16x16x32_bf16 v[24:27], v[88:91], v[44:47], v[24:27]
    v_mfma_f32_16x16x32_bf16 v[28:31], v[92:95], v[44:47], v[28:31]
    ds_read_b64_tr_b16 v[112:113], v8 offset:41472
    ds_read_b64_tr_b16 v[114:115], v8 offset:43520
    ds_read_b64_tr_b16 v[116:117], v9 offset:41472
    ds_read_b64_tr_b16 v[118:119], v9 offset:43520
    ds_read_b64_tr_b16 v[120:121], v10 offset:41472
    ds_read_b64_tr_b16 v[122:123], v10 offset:43520
    ds_read_b64_tr_b16 v[124:125], v11 offset:41472
L_pad9:
    s_cbranch_execz L_ret2
    ds_read_b64_tr_b16 v[126:127], v11 offset:43520
    s_waitcnt lgkmcnt(8)
    v_mfma_f32_16x16x32_bf16 v[16:19], v[96:99], v[48:51], v[16:19]
    v_mfma_f32_16x16x32_bf16 v[20:23], v[100:103], v[48:51], v[20:23]
    v_mfma_f32_16x16x32_bf16 v[24:27], v[104:107], v[48:51], v[24:27]
    v_mfma_f32_16x16x32_bf16 v[28:31], v[108:111], v[48:51], v[28:31]
    ds_read_b64_tr_b16 v[128:129], v8 offset:45568
    ds_read_b64_tr_b16 v[130:131], v8 offset:47616
    ds_read_b64_tr_b16 v[132:133], v9 offset:45568
    ds_read_b64_tr_b16 v[134:135], v9 offset:47616
    ds_read_b64_tr_b16 v[136:137], v10 offset:45568
    ds_read_b64_tr_b16 v[138:139], v10 offset:47616
    ds_read_b64_tr_b16 v[140:141], v11 offset:45568
    ds_read_b64_tr_b16 v[142:143], v11 offset:47616
    s_waitcnt lgkmcnt(8)
    v_mfma_f32_16x16x32_bf16 v[16:19], v[112:115], v[52:55], v[16:19]
    v_mfma_f32_16x16x32_bf16 v[20:23], v[116:119], v[52:55], v[20:23]
    v_mfma_f32_16x16x32_bf16 v[24:27], v[120:123], v[52:55], v[24:27]
    v_mfma_f32_16x16x32_bf16 v[28:31], v[124:127], v[52:55], v[28:31]
    ds_read_b64_tr_b16 v[144:145], v8 offset:49664
    ds_read_b64_tr_b16 v[146:147], v8 offset:51712
    ds_read_b64_tr_b16 v[148:149], v9 offset:49664
    ds_read_b64_tr_b16 v[150:151], v9 offset:51712
    ds_read_b64_tr_b16 v[152:153], v10 offset:49664
    ds_read_b64_tr_b16 v[154:155], v10 offset:51712
    ds_read_b64_tr_b16 v[156:157], v11 offset:49664
    ds_read_b64_tr_b16 v[158:159], v11 offset:51712
    s_waitcnt lgkmcnt(8)
    v_mfma_f32_16x16x32_bf16 v[16:19], v[128:131], v[56:59], v[16:19]
    v_mfma_f32_16x16x32_bf16 v[20:23], v[132:135], v[56:59], v[20:23]
    v_mfma_f32_16x16x32_bf16 v[24:27], v[136:139], v[56:59], v[24:27]
    v_mfma_f32_16x16x32_bf16 v[28:31], v[140:143], v[56:59], v[28:31]
    s_waitcnt lgkmcnt(0)
    v_mfma_f32_16x16x32_bf16 v[16:19], v[144:147], v[60:63], v[16:19]
    v_mfma_f32_16x16x32_bf16 v[20:23], v[148:151], v[60:63], v[20:23]
    v_mfma_f32_16x16x32_bf16 v[24:27], v[152:155], v[60:63], v[24:27]
    v_mfma_f32_16x16x32_bf16 v[28:31], v[156:159], v[60:63], v[28:31]
    s_mov_b32 s66, 0xf0f0f0f0
    s_mov_b32 s67, 0xf0f0f0f0
    s_mov_b32 vcc_lo, 0xff00ff00
    s_mov_b32 vcc_hi, 0xff00ff00
    s_nop 1
    v_cndmask_b32 v16, v16, v20, s[66:67]
    v_cndmask_b32 v17, v17, v21, s[66:67]
    v_cndmask_b32 v18, v18, v22, s[66:67]
    v_cndmask_b32 v19, v19, v23, s[66:67]
    v_cndmask_b32 v24, v24, v28, s[66:67]
    v_cndmask_b32 v25, v25, v29, s[66:67]
    v_cndmask_b32 v26, v26, v30, s[66:67]
    v_cndmask_b32 v27, v27, v31, s[66:67]
    v_cndmask_b32 v16, v16, v24, vcc
    v_cndmask_b32 v17, v17, v25, vcc
    v_cndmask_b32 v18, v18, v26, vcc
    v_cndmask_b32 v19, v19, v27, vcc
    v_and_or_b32 v16, v16, v15, s52
    v_and_or_b32 v17, v17, v15, s53
    v_and_or_b32 v18, v18, v15, s54
    v_and_or_b32 v19, v19, v15, s55
    s_add_u32 s60, s41, 2097152
    buffer_store_dwordx4 v[16:19], v4, s[36:39], s60 offen
    s_mov_b32 s62, 0
L_aw41:
    s_add_u32 s62, s62, 1
    s_cmp_ge_u32 s62, 1000000
    s_cbranch_scc1 L_fail
    s_sleep 1
    ds_read_b32 v32, v38 offset:6480
    s_waitcnt lgkmcnt(0)
    v_readfirstlane_b32 s60, v32
    s_nop 0
    s_cmp_ge_u32 s60, 1
    s_cbranch_scc0 L_aw41
    s_cmp_eq_u32 s60, 1
    s_cbranch_scc1 L_W1_done
    v_xor_b32 v20, s49, v16
    v_xor_b32 v21, s49, v17
    v_xor_b32 v22, s49, v18
    v_xor_b32 v23, s49, v19
    buffer_store_dwordx4 v[20:23], v4, s[36:39], s41 offen sc1
L_W1_done:
    s_add_u32 s63, s69, 2
    s_and_b32 s63, s63, 7
    s_lshl_b32 s63, s63, 2
    s_lshr_b32 s61, s69, 3
    s_add_u32 s63, s63, s61
    s_sub_u32 s60, s63, 8
    s_cmp_lt_u32 s60, 12
    s_cbranch_scc1 L_w_end
    s_sub_u32 s60, s60, 4
    s_cmp_lt_u32 s63, 8
    s_cselect_b32 s63, s63, s60
L_RED:
    s_and_b32 s60, s68, 3
    s_cselect_b32 s60, 16, 24
    s_cmp_ge_u32 s63, s60
    s_cbranch_scc1 L_w_end
    s_lshr_b32 s60, s68, 2
    s_mul_i32 s60, s60, 72
    s_add_u32 s63, s63, s60
    s_and_b32 s60, s68, 3
    s_cselect_b32 s61, 8, 0
    s_lshl_b32 s60, s60, 4
    s_add_u32 s63, s63, s60
    s_add_u32 s63, s63, s61
    s_setprio 3
    s_mov_b32 s32, s20
    s_mov_b32 s33, s21
    s_mov_b32 s34, 0x1200
    s_mov_b32 s35, 0x20000
    v_mul_u32_u24 v3, 1152, v14
    v_lshl_add_u32 v3, v12, 1, v3
    s_lshl_b32 s51, s63, 3
    buffer_load_ushort v4, v3, s[28:31], s51 offen
    v_lshrrev_b32 v13, 2, v1
    v_mul_u32_u24 v2, 128, v13
    v_lshl_add_u32 v2, v14, 4, v2
    s_and_b32 s60, s63, 0xfe
    s_sub_u32 s61, s60, 71
    s_cmp_ge_u32 s60, 72
    s_cselect_b32 s60, s61, s60
    s_xor_b32 s60, s60, 0
    s_lshl_b32 s60, s60, 13
    s_and_b32 s61, s63, 1
    s_lshl_b32 s61, s61, 6
    s_add_u32 s60, s60, s61
    s_add_u32 s60, s60, 851968
    s_add_u32 s64, s24, s60
    s_addc_u32 s65, s25, 0
    s_mov_b32 s52, s60
    s_add_u32 s53, s60, 2048
    s_add_u32 s54, s60, 4096
    s_add_u32 s55, s60, 6144
    s_waitcnt vmcnt(0)
    v_lshlrev_b32 v4, 16, v4
L_red_go:
    s_mov_b32 s50, 1
    s_mov_b32 s62, 0
L_aw42:
    s_add_u32 s62, s62, 1
    s_cmp_ge_u32 s62, 1000000
    s_cbranch_scc1 L_fail
L_pad10:
    s_cbranch_execz L_ret2
    s_sleep 1
    ds_read_b32 v32, v38 offset:6468
    s_waitcnt lgkmcnt(0)
    v_readfirstlane_b32 s60, v32
    s_nop 0
    s_cmp_ge_u32 s60, 4
    s_cbranch_scc0 L_aw42
    s_mov_b32 s66, 0xff
    s_mov_b32 s67, 0xff
    s_mov_b32 s62, 0
L_hint:
    s_add_u32 s62, s62, 1
    s_cmp_ge_u32 s62, 1000000
    s_cbranch_scc1 L_fail
    s_load_dwordx2 s[4:5], s[64:65], 0x0 glc
    s_load_dwordx2 s[6:7], s[64:65], 0x480 glc
    s_load_dwordx2 s[8:9], s[64:65], 0x900 glc
    s_load_dwordx2 s[10:11], s[64:65], 0xd80 glc
    s_load_dwordx2 s[12:13], s[64:65], 0x1280 glc
    s_load_dwordx2 s[14:15], s[64:65], 0x1700 glc
    s_load_dwordx2 s[16:17], s[64:65], 0x1c80 glc
    s_waitcnt lgkmcnt(0)
    s_xor_b64 s[4:5], s[4:5], s[56:57]
    s_xor_b64 s[6:7], s[6:7], s[56:57]
    s_or_b64 s[4:5], s[4:5], s[6:7]
    s_xor_b64 s[8:9], s[8:9], s[56:57]
    s_or_b64 s[4:5], s[4:5], s[8:9]
    s_xor_b64 s[10:11], s[10:11], s[56:57]
    s_or_b64 s[4:5], s[4:5], s[10:11]
    s_xor_b64 s[12:13], s[12:13], s[56:57]
    s_or_b64 s[4:5], s[4:5], s[12:13]
    s_xor_b64 s[14:15], s[14:15], s[56:57]
    s_or_b64 s[4:5], s[4:5], s[14:15]
    s_xor_b64 s[16:17], s[16:17], s[56:57]
    s_or_b64 s[4:5], s[4:5], s[16:17]
    s_and_b64 s[4:5], s[4:5], s[66:67]
    s_cbranch_scc1 L_hint
    s_mov_b32 s62, 0
L_h3_0:
    s_add_u32 s62, s62, 1
    s_cmp_ge_u32 s62, 1000000
    s_cbranch_scc1 L_fail
    buffer_load_dwordx4 v[64:67], v2, s[36:39], s52 offen sc1
    buffer_load_dwordx4 v[68:71], v2, s[36:39], s53 offen sc1
    buffer_load_dwordx4 v[72:75], v2, s[36:39], s54 offen sc1
    buffer_load_dwordx4 v[76:79], v2, s[36:39], s55 offen sc1
    s_waitcnt vmcnt(3)
    v_xor_b32 v64, s56, v64
    v_xor_b32 v65, s57, v65
    v_xor_b32 v66, s58, v66
    v_xor_b32 v67, s59, v67
    s_waitcnt vmcnt(2)
    v_xor_b32 v68, s56, v68
    v_xor_b32 v69, s57, v69
    v_xor_b32 v70, s58, v70
    v_xor_b32 v71, s59, v71
    v_pk_add_f32 v[16:17], v[64:65], v[68:69]
    v_pk_add_f32 v[18:19], v[66:67], v[70:71]
    v_or3_b32 v32, v64, v65, v66
    v_or3_b32 v33, v67, v68, v69
    v_or3_b32 v32, v32, v70, v71
    s_waitcnt vmcnt(1)
    v_xor_b32 v72, s56, v72
    v_xor_b32 v73, s57, v73
    v_xor_b32 v74, s58, v74
    v_xor_b32 v75, s59, v75
    v_or3_b32 v33, v33, v72, v73
    v_or3_b32 v32, v32, v74, v75
    s_waitcnt vmcnt(0)
    v_xor_b32 v76, s56, v76
    v_xor_b32 v77, s57, v77
    v_xor_b32 v78, s58, v78
    v_xor_b32 v79, s59, v79
    v_pk_add_f32 v[24:25], v[72:73], v[76:77]
    v_pk_add_f32 v[26:27], v[74:75], v[78:79]
    v_or3_b32 v33, v33, v76, v77
    v_permlane32_swap_b32 v16, v24
    v_permlane32_swap_b32 v17, v25
    v_permlane32_swap_b32 v18, v26
    v_permlane32_swap_b32 v19, v27
    v_pk_add_f32 v[16:17], v[16:17], v[24:25]
    v_pk_add_f32 v[18:19], v[18:19], v[26:27]
    v_or3_b32 v32, v32, v78, v79
    v_permlane16_swap_b32 v16, v17
    v_permlane16_swap_b32 v18, v19
    v_add_f32 v16, v16, v17
    v_add_f32 v18, v18, v19
    v_or_b32 v32, v32, v33
    v_add_f32_dpp v16, v16, v16 row_ror:4 row_mask:0xf bank_mask:0xf
    v_add_f32_dpp v18, v18, v18 row_ror:4 row_mask:0xf bank_mask:0xf
    v_and_b32 v32, 0xff, v32
    v_add_f32_dpp v16, v16, v16 row_ror:8 row_mask:0xf bank_mask:0xf
    v_add_f32_dpp v18, v18, v18 row_ror:8 row_mask:0xf bank_mask:0xf
    v_cmp_ne_u32 vcc, 0, v32
L_h3_done:
    s_nop 0
    v_permlane32_swap_b32 v16, v18
    v_cvt_pk_bf16_f32 v16, v16, v18
    v_and_b32 v18, 0xffff0000, v16
    v_lshlrev_b32 v16, 16, v16
    s_cbranch_vccnz L_h3_0
    v_mul_f32 v19, 0xbfb8aa3b, v18
    v_exp_f32 v19, v19
    s_nop 0
    v_add_f32 v19, 1.0, v19
    v_rcp_f32 v19, v19
    s_nop 0
    v_mul_f32 v18, v18, v19
    v_cvt_pk_bf16_f32 v18, v18, v18
    v_and_b32 v18, 0xffff0000, v18
    v_mul_f32 v16, v16, v18
    v_cvt_pk_bf16_f32 v16, v16, v16
    v_and_b32 v16, 0xffff0000, v16
    v_add_f32 v16, v16, v4
    v_cvt_pk_bf16_f32 v16, v16, v16
    s_mov_b32 exec_lo, 0x000f000f
    s_mov_b32 exec_hi, 0x000f000f
    buffer_store_short v16, v3, s[32:35], s51 offen
    s_cmp_eq_u32 s63, 0
    s_cbranch_scc0 L_red_end
    v_mov_b32 v16, s27
    s_mov_b64 exec, 1
    buffer_store_dword v16, v38, s[36:39], 0 offen
L_red_end:
L_w_end:
    s_endpgm
L_fail:
    s_mov_b64 exec, 1
    v_mov_b32 v1, 0
    v_mov_b32 v2, 1
    global_atomic_add v1, v2, s[22:23]
L_end:
    s_endpgm
.section .rodata,"a"
.p2align 6
.amdhsa_kernel recurrent_scan__sliding_block_cached__dense_activation_silu__decode_kernel
  .amdhsa_next_free_vgpr 168
  .amdhsa_next_free_sgpr 102
  .amdhsa_accum_offset 168
  .amdhsa_group_segment_fixed_size 0
  .amdhsa_kernarg_size 88
  .amdhsa_user_sgpr_count 2
  .amdhsa_user_sgpr_kernarg_segment_ptr 1
  .amdhsa_system_sgpr_workgroup_id_x 1
  .amdhsa_float_denorm_mode_32 3
.end_amdhsa_kernel
```
